```python
import torch

def _softmax(x, axis=-1):
    return torch.softmax(x, dim=axis)
def _gelu(x):
    return torch.nn.functional.gelu(x, approximate="tanh")
def _silu(x):
    return torch.nn.functional.silu(x)
def _sigmoid(x):
    return torch.sigmoid(x)
def _layernorm(x, axis=-1, eps=1e-5):
    m = x.mean(dim=axis, keepdim=True)
    v = x.var(dim=axis, keepdim=True, unbiased=False)
    return (x - m) / torch.sqrt(v + eps)
def _scatter_add(tgt, idx, src, axis=0):
    return tgt.clone().index_add_(axis, idx, src)
def _segment_sum(src, seg, n):
    out = torch.zeros((n,) + src.shape[1:], dtype=src.dtype)
    return out.index_add_(0, seg, src)
def _pad(x, pw):
    flat = tuple(v for pair in reversed(pw) for v in pair)
    return torch.nn.functional.pad(x, flat)

kernel_name = 'gather_scatter__molecular_angular_gemnet__graph'

def setup_inputs():

    _w = (lambda a: (lambda t: t.to(torch.bfloat16) if t.is_floating_point() else t)(torch.as_tensor(a)))
    N, deg, De, L = 10000, 16, 4, 3
    E = N * deg
    T = E * deg
    NR = 8
    dist = torch.rand(E).to(float)
    angle = (torch.rand(T) * torch.pi).to(float)
    centers = torch.linspace(0.0, 1.0, NR).to(float)
    ang_freq = torch.arange(1, L + 1).to(float)
    return {
        "m": _w((lambda *s: torch.randn(*s, dtype=torch.bfloat16) * 0.05)(E, De)),
        "idx_in": _w((lambda lo, hi, *s: torch.randint(lo, hi, s))(0, E, T).to(torch.int64)),
        "idx_out": _w((lambda lo, hi, *s: torch.randint(lo, hi, s))(0, E, T).to(torch.int64)),
        "dist": _w(dist),
        "angle": _w(angle),
        "centers": _w(centers),
        "ang_freq": _w(ang_freq),
        "w_rbf": _w((lambda *s: torch.randn(*s, dtype=torch.bfloat16) * 0.2)(NR, De)),
        "w_sbf": _w((lambda *s: torch.randn(*s, dtype=torch.bfloat16) * 0.2)(NR * L, De)),
        "w_down": _w((lambda *s: torch.randn(*s, dtype=torch.bfloat16) * 0.2)(De, De)),
        "w_up": _w((lambda *s: torch.randn(*s, dtype=torch.bfloat16) * 0.2)(De, De)),
    }

def reference(m, idx_in, idx_out, dist, angle, centers, ang_freq, w_rbf, w_sbf, w_down, w_up):
    E, De = m.shape[0], m.shape[1]
    NR = centers.shape[0]
    L = ang_freq.shape[0]
    rbf = torch.exp(-10.0 * (dist[:, None] - centers[None, :]) ** 2)
    cbf = torch.cos(ang_freq[None, :] * angle[:, None])
    rbf_t = rbf[idx_out]
    sbf = torch.reshape(rbf_t[:, :, None] * cbf[:, None, :], (-1, NR * L))
    x = (m[idx_in] @ w_down) * (sbf @ w_sbf)
    agg = _segment_sum(x, idx_out, E)
    return m + (agg @ w_up) * (rbf @ w_rbf)
```

```asm
; @launch kernel=gs_part_kernel grid=(256,1,1) block=(1024,1,1) lds=81920
; @launch kernel=gather_scatter__molecular_angular_gemnet__graph_kernel grid=(256,1,1) block=(1024,1,1) lds=114432
.amdgcn_target "amdgcn-amd-amdhsa--gfx950"
.text
.globl gs_part_kernel
.p2align 8
.type gs_part_kernel,@function
gs_part_kernel:
  s_cmp_ge_u32 s2, 256
  s_cbranch_scc1 L_k1_exit
  s_load_dwordx4 s[80:83], s[0:1], 8
  s_load_dwordx2 s[84:85], s[0:1], 32
  s_load_dwordx2 s[86:87], s[0:1], 0
  s_load_dwordx2 s[88:89], s[0:1], 104
  v_lshlrev_b32 v1, 4, v0
  v_lshlrev_b32 v2, 3, v0
  v_lshlrev_b32 v3, 2, v0
  v_mov_b32 v4, 16
  v_mov_b32 v5, 0
  v_lshrrev_b32 v8, 6, v0
  v_cmp_gt_u32 vcc, 1000, v0
  s_mul_i32 s94, s2, 40000
  s_mul_i32 s95, s2, 20000
  s_mul_i32 s93, s2, 5000
  v_readfirstlane_b32 s3, v8
  s_mov_b64 s[28:29], vcc
  v_add_u32 v9, 16384, v1
  v_mov_b32 v76, -1
  v_mov_b32 v77, -1
  v_mov_b32 v78, -1
  v_mov_b32 v79, -1
  v_mov_b32 v72, 0
  v_mov_b32 v73, 0
  v_mov_b32 v74, 0
  v_mov_b32 v75, 0
  s_mov_b32 s30, 6871948
  s_mov_b32 s31, -2500
  s_mov_b32 s32, 384
  s_mov_b32 s44, 896
  s_mov_b32 s34, -124
  s_mov_b32 s35, -127
  s_mov_b32 s33, 32768
  v_lshrrev_b32 v95, 3, v0
  v_and_b32 v10, 7, v0
  v_lshlrev_b32 v95, 8, v95
  v_lshl_or_b32 v95, v10, 4, v95
  v_add_u32 v6, 16384, v95
  s_mov_b32 s36, 16000
  s_mov_b32 s37, 32000
  s_mov_b32 s38, 8000
  s_mov_b32 s39, 16000
  s_mov_b32 s42, 0x7fff7fff
  s_mov_b32 s43, 0xffff0000
  s_mov_b32 s41, 0x32803280
  v_mov_b32 v49, 0
  s_waitcnt lgkmcnt(0)
  s_add_u32 s4, s82, s94
  s_addc_u32 s5, s83, 0
  s_mov_b32 s6, 0x9c40
  s_mov_b32 s7, 0x20000
  s_add_u32 s8, s80, s94
  s_addc_u32 s9, s81, 0
  s_mov_b32 s10, 0x9c40
  s_mov_b32 s11, 0x20000
  s_add_u32 s12, s84, s95
  s_addc_u32 s13, s85, 0
  s_mov_b32 s14, 0x4e20
  s_mov_b32 s15, 0x20000
  s_add_u32 s16, s86, s93
  s_addc_u32 s17, s87, 0
  s_mov_b32 s18, 0x1388
  s_mov_b32 s19, 0x20000
  buffer_load_dwordx2 v[70:71], v2, s[16:19], 0 offen nt
  s_mov_b64 exec, s[28:29]
  buffer_load_dwordx4 v[24:27], v1, s[4:7], 0 offen nt
  buffer_load_dwordx2 v[32:33], v2, s[4:7], s37 offen nt
  s_mov_b64 exec, -1
  s_mul_i32 s94, s2, 65536
  s_add_u32 s20, s88, s94
  s_addc_u32 s21, s89, 0
  s_mov_b32 s22, 0x10000
  s_mov_b32 s23, 0x20000
  s_mov_b32 s24, s88
  s_mov_b32 s25, s89
  s_mov_b32 s26, 0x4000000
  s_mov_b32 s27, 0x20000
  s_mul_i32 s40, s2, 65792
  s_add_u32 s40, s40, 0x10fff40
  ds_write_b128 v1, v[72:75]
  ds_write_b128 v9, v[76:79] offset:0
  ds_write_b128 v9, v[76:79] offset:16384
  ds_write_b128 v9, v[76:79] offset:32768
  ds_write_b128 v9, v[76:79] offset:49152
  s_waitcnt lgkmcnt(0)
  s_barrier
  s_mov_b64 exec, s[28:29]
  buffer_load_dwordx4 v[34:37], v1, s[8:11], 0 offen nt
  buffer_load_dwordx2 v[44:45], v2, s[12:15], 0 offen nt
  buffer_load_dwordx2 v[42:43], v2, s[8:11], s37 offen nt
  buffer_load_dword v48, v3, s[12:15], s39 offen nt
  s_mov_b64 exec, -1
  s_waitcnt vmcnt(6)
  v_and_b32 v8, s42, v70
  v_and_b32 v9, s42, v71
  v_lshlrev_b32 v12, 16, v70
  v_and_b32 v13, s43, v70
  v_pk_max_u16 v8, v8, v9
  v_lshlrev_b32 v14, 16, v71
  v_and_b32 v15, s43, v71
  v_lshrrev_b32 v9, 16, v8
  v_and_b32 v8, 0xffff, v8
  v_add_f32 v12, |v12|, |v13|
  v_add_f32 v14, |v14|, |v15|
  v_max_u32 v88, v8, v9
  v_add_f32 v89, v12, v14
  s_nop 0
  s_nop 1
  s_nop 0
  v_max_u32_dpp v88, v88, v88 row_shr:1 row_mask:0xf bank_mask:0xf bound_ctrl:0
  v_add_f32_dpp v89, v89, v89 row_shr:1 row_mask:0xf bank_mask:0xf bound_ctrl:0
  s_nop 0
  v_max_u32_dpp v88, v88, v88 row_shr:2 row_mask:0xf bank_mask:0xf bound_ctrl:0
  v_add_f32_dpp v89, v89, v89 row_shr:2 row_mask:0xf bank_mask:0xf bound_ctrl:0
  s_nop 0
  v_max_u32_dpp v88, v88, v88 row_shr:4 row_mask:0xf bank_mask:0xf bound_ctrl:0
  v_add_f32_dpp v89, v89, v89 row_shr:4 row_mask:0xf bank_mask:0xf bound_ctrl:0
  s_nop 0
  v_max_u32_dpp v88, v88, v88 row_shr:8 row_mask:0xf bank_mask:0xf bound_ctrl:0
  v_add_f32_dpp v89, v89, v89 row_shr:8 row_mask:0xf bank_mask:0xf bound_ctrl:0
  s_nop 0
  v_max_u32_dpp v88, v88, v88 row_bcast:15 row_mask:0xa bank_mask:0xf
  v_add_f32_dpp v89, v89, v89 row_bcast:15 row_mask:0xa bank_mask:0xf
  s_nop 0
  v_max_u32_dpp v88, v88, v88 row_bcast:31 row_mask:0xc bank_mask:0xf
  v_add_f32_dpp v89, v89, v89 row_bcast:31 row_mask:0xc bank_mask:0xf
  s_mov_b32 exec_lo, 0
  s_mov_b32 exec_hi, 0x80000000
  ds_max_u32 v5, v88 offset:2048
  ds_add_f32 v5, v89 offset:2052
  s_mov_b64 exec, s[28:29]
  s_waitcnt vmcnt(5)
  v_mul_hi_u32_u24 v50, s30, v24
  v_mul_hi_u32_u24 v51, s30, v25
  v_mul_hi_u32_u24 v52, s30, v26
  v_mul_hi_u32_u24 v53, s30, v27
  v_lshlrev_b32 v24, 4, v24
  v_lshlrev_b32 v50, 2, v50
  v_lshlrev_b32 v25, 4, v25
  v_lshlrev_b32 v51, 2, v51
  v_lshlrev_b32 v26, 4, v26
  v_lshlrev_b32 v52, 2, v52
  v_lshlrev_b32 v27, 4, v27
  v_lshlrev_b32 v53, 2, v53
  ds_add_rtn_u32 v60, v50, v4 offset:4096
  ds_add_rtn_u32 v61, v51, v4 offset:4096
  ds_add_rtn_u32 v62, v52, v4 offset:4096
  ds_add_rtn_u32 v63, v53, v4 offset:4096
  v_mad_i32_i24 v24, v50, s31, v24
  v_mad_i32_i24 v25, v51, s31, v25
  v_mad_i32_i24 v26, v52, s31, v26
  v_mad_i32_i24 v27, v53, s31, v27
  s_waitcnt vmcnt(4)
  v_mul_hi_u32_u24 v58, s30, v32
  v_mul_hi_u32_u24 v59, s30, v33
  v_lshlrev_b32 v32, 4, v32
  v_lshlrev_b32 v58, 2, v58
  v_lshlrev_b32 v33, 4, v33
  v_lshlrev_b32 v59, 2, v59
  ds_add_rtn_u32 v68, v58, v4 offset:4096
  ds_add_rtn_u32 v69, v59, v4 offset:4096
  v_mad_i32_i24 v32, v58, s31, v32
  v_mad_i32_i24 v33, v59, s31, v33
  s_mov_b64 exec, -1
  s_barrier
  s_mov_b64 exec, s[28:29]
  buffer_load_dwordx4 v[28:31], v1, s[4:7], s36 offen nt
  buffer_load_dwordx4 v[38:41], v1, s[8:11], s36 offen nt
  buffer_load_dwordx2 v[46:47], v2, s[12:15], s38 offen nt
  s_waitcnt lgkmcnt(0)
  v_cmp_le_u32 s[48:49], s32, v60
  v_cmp_le_u32 s[50:51], s32, v61
  v_cmp_le_u32 s[52:53], s32, v62
  v_cmp_le_u32 s[54:55], s32, v63
  v_cmp_le_u32 s[56:57], s32, v68
  v_cmp_le_u32 s[58:59], s32, v69
  s_mov_b64 exec, s[48:49]
  ds_add_rtn_u32 v60, v50, v4
  v_add_u32 v50, 2, v50
  s_mov_b64 exec, s[50:51]
  ds_add_rtn_u32 v61, v51, v4
  v_add_u32 v51, 2, v51
  s_mov_b64 exec, s[52:53]
  ds_add_rtn_u32 v62, v52, v4
  v_add_u32 v52, 2, v52
  s_mov_b64 exec, s[54:55]
  ds_add_rtn_u32 v63, v53, v4
  v_add_u32 v53, 2, v53
  s_mov_b64 exec, s[56:57]
  ds_add_rtn_u32 v68, v58, v4
  v_add_u32 v58, 2, v58
  s_mov_b64 exec, s[58:59]
  ds_add_rtn_u32 v69, v59, v4
  v_add_u32 v59, 2, v59
  s_mov_b64 exec, s[28:29]
  s_waitcnt vmcnt(5)
  v_and_b32 v44, s42, v44
  v_and_b32 v45, s42, v45
  v_lshl_or_b32 v34, v34, 14, v24
  v_lshl_or_b32 v35, v35, 14, v25
  v_lshl_or_b32 v36, v36, 14, v26
  v_lshl_or_b32 v37, v37, 14, v27
  v_pk_max_u16 v49, v49, v44
  v_pk_sub_u16 v44, v44, s41 clamp
  v_pk_max_u16 v49, v49, v45
  v_pk_sub_u16 v45, v45, s41 clamp
  s_nop 0
  v_or_b32_sdwa v34, v34, v44 dst_sel:DWORD dst_unused:UNUSED_PAD src0_sel:DWORD src1_sel:BYTE_1
  v_or_b32_sdwa v35, v35, v44 dst_sel:DWORD dst_unused:UNUSED_PAD src0_sel:DWORD src1_sel:BYTE_3
  v_or_b32_sdwa v36, v36, v45 dst_sel:DWORD dst_unused:UNUSED_PAD src0_sel:DWORD src1_sel:BYTE_1
  v_or_b32_sdwa v37, v37, v45 dst_sel:DWORD dst_unused:UNUSED_PAD src0_sel:DWORD src1_sel:BYTE_3
  s_waitcnt lgkmcnt(0)
  v_lshl_add_u32 v8, v50, 6, v60
  v_lshrrev_b32 v24, 7, v60
  v_lshl_add_u32 v9, v51, 6, v61
  v_lshrrev_b32 v25, 7, v61
  v_lshl_add_u32 v10, v52, 6, v62
  v_lshrrev_b32 v26, 7, v62
  v_lshl_add_u32 v11, v53, 6, v63
  v_lshrrev_b32 v27, 7, v63
  v_cmp_gt_u32 s[48:49], s32, v60
  v_mad_i32_i24 v14, v24, s34, v8
  v_cmp_gt_u32 s[50:51], s32, v61
  v_mad_i32_i24 v15, v25, s34, v9
  v_cmp_gt_u32 s[52:53], s32, v62
  v_mad_i32_i24 v16, v26, s34, v10
  v_cmp_gt_u32 s[54:55], s32, v63
  v_mad_i32_i24 v17, v27, s34, v11
  v_mad_i32_i24 v8, v24, s35, v8
  v_mad_i32_i24 v9, v25, s35, v9
  v_mad_i32_i24 v10, v26, s35, v10
  v_mad_i32_i24 v11, v27, s35, v11
  v_max3_u32 v92, v60, v61, v62
  v_max_u32 v92, v92, v63
  s_mov_b64 exec, s[48:49]
  ds_write_b32 v14, v34 offset:16384
  ds_write_b8 v8, v44 offset:16396
  s_mov_b64 exec, s[50:51]
  ds_write_b32 v15, v35 offset:16384
  ds_write_b8_d16_hi v9, v44 offset:16396
  s_mov_b64 exec, s[52:53]
  ds_write_b32 v16, v36 offset:16384
  ds_write_b8 v10, v45 offset:16396
  s_mov_b64 exec, s[54:55]
  ds_write_b32 v17, v37 offset:16384
  ds_write_b8_d16_hi v11, v45 offset:16396
  s_mov_b64 exec, s[28:29]
  v_cmp_le_u32 vcc, s32, v92
  s_cbranch_vccz L_k1_not2_1
  v_lshrrev_b32 v8, 1, v60
  v_cmp_gt_u32 s[60:61], s44, v60
  v_lshrrev_b32 v9, 1, v61
  v_cmp_gt_u32 s[62:63], s44, v61
  v_lshrrev_b32 v10, 1, v62
  v_cmp_gt_u32 s[64:65], s44, v62
  v_lshrrev_b32 v11, 1, v63
  v_cmp_gt_u32 s[66:67], s44, v63
  v_lshl_add_u32 v8, v50, 6, v8
  s_andn2_b64 s[60:61], s[60:61], s[48:49]
  v_lshl_add_u32 v9, v51, 6, v9
  s_andn2_b64 s[62:63], s[62:63], s[50:51]
  v_lshl_add_u32 v10, v52, 6, v10
  s_andn2_b64 s[64:65], s[64:65], s[52:53]
  v_lshl_add_u32 v11, v53, 6, v11
  s_andn2_b64 s[66:67], s[66:67], s[54:55]
  s_sub_u32 s94, s40, 128
  s_mov_b64 exec, s[60:61]
  buffer_store_dword v34, v8, s[24:27], s94 offen
  buffer_store_short v44, v8, s[24:27], s94 offen offset:4
  s_mov_b64 exec, s[62:63]
  buffer_store_dword v35, v9, s[24:27], s94 offen
  buffer_store_short_d16_hi v44, v9, s[24:27], s94 offen offset:4
  s_mov_b64 exec, s[64:65]
  buffer_store_dword v36, v10, s[24:27], s94 offen
  buffer_store_short v45, v10, s[24:27], s94 offen offset:4
  s_mov_b64 exec, s[66:67]
  buffer_store_dword v37, v11, s[24:27], s94 offen
  buffer_store_short_d16_hi v45, v11, s[24:27], s94 offen offset:4
  s_mov_b64 exec, s[28:29]
L_k1_not2_1:
  s_waitcnt vmcnt(3)
  v_and_b32 v48, s42, v48
  v_lshl_or_b32 v42, v42, 14, v32
  v_lshl_or_b32 v43, v43, 14, v33
  v_pk_max_u16 v49, v49, v48
  v_pk_sub_u16 v48, v48, s41 clamp
  s_nop 0
  v_or_b32_sdwa v42, v42, v48 dst_sel:DWORD dst_unused:UNUSED_PAD src0_sel:DWORD src1_sel:BYTE_1
  v_or_b32_sdwa v43, v43, v48 dst_sel:DWORD dst_unused:UNUSED_PAD src0_sel:DWORD src1_sel:BYTE_3
  s_waitcnt lgkmcnt(0)
  v_lshl_add_u32 v8, v58, 6, v68
  v_lshrrev_b32 v32, 7, v68
  v_lshl_add_u32 v9, v59, 6, v69
  v_lshrrev_b32 v33, 7, v69
  v_cmp_gt_u32 s[48:49], s32, v68
  v_mad_i32_i24 v14, v32, s34, v8
  v_cmp_gt_u32 s[50:51], s32, v69
  v_mad_i32_i24 v15, v33, s34, v9
  v_mad_i32_i24 v8, v32, s35, v8
  v_mad_i32_i24 v9, v33, s35, v9
  v_max_u32 v92, v68, v69
  s_mov_b64 exec, s[48:49]
  ds_write_b32 v14, v42 offset:16384
  ds_write_b8 v8, v48 offset:16396
  s_mov_b64 exec, s[50:51]
  ds_write_b32 v15, v43 offset:16384
  ds_write_b8_d16_hi v9, v48 offset:16396
  s_mov_b64 exec, s[28:29]
  v_cmp_le_u32 vcc, s32, v92
  s_cbranch_vccz L_k1_not2_2
  v_lshrrev_b32 v8, 1, v68
  v_cmp_gt_u32 s[60:61], s44, v68
  v_lshrrev_b32 v9, 1, v69
  v_cmp_gt_u32 s[62:63], s44, v69
  v_lshl_add_u32 v8, v58, 6, v8
  s_andn2_b64 s[60:61], s[60:61], s[48:49]
  v_lshl_add_u32 v9, v59, 6, v9
  s_andn2_b64 s[62:63], s[62:63], s[50:51]
  s_sub_u32 s94, s40, 128
  s_mov_b64 exec, s[60:61]
  buffer_store_dword v42, v8, s[24:27], s94 offen
  buffer_store_short v48, v8, s[24:27], s94 offen offset:4
  s_mov_b64 exec, s[62:63]
  buffer_store_dword v43, v9, s[24:27], s94 offen
  buffer_store_short_d16_hi v48, v9, s[24:27], s94 offen offset:4
  s_mov_b64 exec, s[28:29]
L_k1_not2_2:
  s_mov_b64 exec, -1
  s_waitcnt lgkmcnt(0)
  s_barrier
  ds_read_b128 v[76:79], v6 offset:0
  ds_read_b128 v[80:83], v6 offset:32768
  s_waitcnt lgkmcnt(1)
  buffer_store_dwordx4 v[76:79], v95, s[20:23], 0 offen
  s_waitcnt lgkmcnt(0)
  buffer_store_dwordx4 v[80:83], v95, s[20:23], s33 offen
  s_mov_b64 exec, s[28:29]
  s_waitcnt vmcnt(4)
  v_mul_hi_u32_u24 v54, s30, v28
  v_mul_hi_u32_u24 v55, s30, v29
  v_mul_hi_u32_u24 v56, s30, v30
  v_mul_hi_u32_u24 v57, s30, v31
  v_lshlrev_b32 v28, 4, v28
  v_lshlrev_b32 v54, 2, v54
  v_lshlrev_b32 v29, 4, v29
  v_lshlrev_b32 v55, 2, v55
  v_lshlrev_b32 v30, 4, v30
  v_lshlrev_b32 v56, 2, v56
  v_lshlrev_b32 v31, 4, v31
  v_lshlrev_b32 v57, 2, v57
  ds_add_rtn_u32 v64, v54, v4 offset:0
  ds_add_rtn_u32 v65, v55, v4 offset:0
  ds_add_rtn_u32 v66, v56, v4 offset:0
  ds_add_rtn_u32 v67, v57, v4 offset:0
  v_mad_i32_i24 v28, v54, s31, v28
  v_mad_i32_i24 v29, v55, s31, v29
  v_mad_i32_i24 v30, v56, s31, v30
  v_mad_i32_i24 v31, v57, s31, v31
  s_waitcnt vmcnt(2)
  v_and_b32 v46, s42, v46
  v_and_b32 v47, s42, v47
  v_lshl_or_b32 v38, v38, 14, v28
  v_lshl_or_b32 v39, v39, 14, v29
  v_lshl_or_b32 v40, v40, 14, v30
  v_lshl_or_b32 v41, v41, 14, v31
  v_pk_max_u16 v49, v49, v46
  v_pk_sub_u16 v46, v46, s41 clamp
  v_pk_max_u16 v49, v49, v47
  v_pk_sub_u16 v47, v47, s41 clamp
  s_nop 0
  v_or_b32_sdwa v38, v38, v46 dst_sel:DWORD dst_unused:UNUSED_PAD src0_sel:DWORD src1_sel:BYTE_1
  v_or_b32_sdwa v39, v39, v46 dst_sel:DWORD dst_unused:UNUSED_PAD src0_sel:DWORD src1_sel:BYTE_3
  v_or_b32_sdwa v40, v40, v47 dst_sel:DWORD dst_unused:UNUSED_PAD src0_sel:DWORD src1_sel:BYTE_1
  v_or_b32_sdwa v41, v41, v47 dst_sel:DWORD dst_unused:UNUSED_PAD src0_sel:DWORD src1_sel:BYTE_3
  s_waitcnt lgkmcnt(0)
  v_lshl_add_u32 v8, v54, 6, v64
  v_lshrrev_b32 v28, 7, v64
  v_lshl_add_u32 v9, v55, 6, v65
  v_lshrrev_b32 v29, 7, v65
  v_lshl_add_u32 v10, v56, 6, v66
  v_lshrrev_b32 v30, 7, v66
  v_lshl_add_u32 v11, v57, 6, v67
  v_lshrrev_b32 v31, 7, v67
  v_cmp_gt_u32 s[48:49], s32, v64
  v_mad_i32_i24 v14, v28, s34, v8
  v_cmp_gt_u32 s[50:51], s32, v65
  v_mad_i32_i24 v15, v29, s34, v9
  v_cmp_gt_u32 s[52:53], s32, v66
  v_mad_i32_i24 v16, v30, s34, v10
  v_cmp_gt_u32 s[54:55], s32, v67
  v_mad_i32_i24 v17, v31, s34, v11
  v_mad_i32_i24 v8, v28, s35, v8
  v_mad_i32_i24 v9, v29, s35, v9
  v_mad_i32_i24 v10, v30, s35, v10
  v_mad_i32_i24 v11, v31, s35, v11
  v_max3_u32 v92, v64, v65, v66
  v_max_u32 v92, v92, v67
  s_mov_b64 exec, s[48:49]
  ds_write_b32 v14, v38 offset:16512
  ds_write_b8 v8, v46 offset:16524
  s_mov_b64 exec, s[50:51]
  ds_write_b32 v15, v39 offset:16512
  ds_write_b8_d16_hi v9, v46 offset:16524
  s_mov_b64 exec, s[52:53]
  ds_write_b32 v16, v40 offset:16512
  ds_write_b8 v10, v47 offset:16524
  s_mov_b64 exec, s[54:55]
  ds_write_b32 v17, v41 offset:16512
  ds_write_b8_d16_hi v11, v47 offset:16524
  s_mov_b64 exec, s[28:29]
  v_cmp_le_u32 vcc, s32, v92
  s_cbranch_vccz L_k1_not2_3
  v_lshrrev_b32 v8, 1, v64
  v_cmp_gt_u32 s[60:61], s44, v64
  v_lshrrev_b32 v9, 1, v65
  v_cmp_gt_u32 s[62:63], s44, v65
  v_lshrrev_b32 v10, 1, v66
  v_cmp_gt_u32 s[64:65], s44, v66
  v_lshrrev_b32 v11, 1, v67
  v_cmp_gt_u32 s[66:67], s44, v67
  v_lshl_add_u32 v8, v54, 6, v8
  s_andn2_b64 s[60:61], s[60:61], s[48:49]
  v_lshl_add_u32 v9, v55, 6, v9
  s_andn2_b64 s[62:63], s[62:63], s[50:51]
  v_lshl_add_u32 v10, v56, 6, v10
  s_andn2_b64 s[64:65], s[64:65], s[52:53]
  v_lshl_add_u32 v11, v57, 6, v11
  s_andn2_b64 s[66:67], s[66:67], s[54:55]
  s_mov_b64 exec, s[60:61]
  buffer_store_dword v38, v8, s[24:27], s40 offen
  buffer_store_short v46, v8, s[24:27], s40 offen offset:4
  s_mov_b64 exec, s[62:63]
  buffer_store_dword v39, v9, s[24:27], s40 offen
  buffer_store_short_d16_hi v46, v9, s[24:27], s40 offen offset:4
  s_mov_b64 exec, s[64:65]
  buffer_store_dword v40, v10, s[24:27], s40 offen
  buffer_store_short v47, v10, s[24:27], s40 offen offset:4
  s_mov_b64 exec, s[66:67]
  buffer_store_dword v41, v11, s[24:27], s40 offen
  buffer_store_short_d16_hi v47, v11, s[24:27], s40 offen offset:4
  s_mov_b64 exec, s[28:29]
L_k1_not2_3:
  s_mov_b64 exec, -1
  v_lshrrev_b32 v9, 16, v49
  v_and_b32 v8, 0xffff, v49
  v_max_u32 v8, v8, v9
  s_nop 1
  s_nop 1
  v_max_u32_dpp v8, v8, v8 row_shr:1 row_mask:0xf bank_mask:0xf bound_ctrl:0
  s_nop 1
  v_max_u32_dpp v8, v8, v8 row_shr:2 row_mask:0xf bank_mask:0xf bound_ctrl:0
  s_nop 1
  v_max_u32_dpp v8, v8, v8 row_shr:4 row_mask:0xf bank_mask:0xf bound_ctrl:0
  s_nop 1
  v_max_u32_dpp v8, v8, v8 row_shr:8 row_mask:0xf bank_mask:0xf bound_ctrl:0
  s_nop 1
  v_max_u32_dpp v8, v8, v8 row_bcast:15 row_mask:0xa bank_mask:0xf
  s_nop 1
  v_max_u32_dpp v8, v8, v8 row_bcast:31 row_mask:0xc bank_mask:0xf
  s_mov_b32 exec_lo, 0
  s_mov_b32 exec_hi, 0x80000000
  ds_max_u32 v5, v8 offset:2056
  s_mov_b64 exec, -1
  s_waitcnt lgkmcnt(0)
  s_barrier
  ds_read_b128 v[104:107], v6 offset:128
  ds_read_b128 v[108:111], v6 offset:32896
  ds_read_b96 v[8:10], v5 offset:2048
  ds_read_b32 v12, v3
  s_waitcnt lgkmcnt(3)
  buffer_store_dwordx4 v[104:107], v95, s[20:23], 0 offen offset:128
  s_waitcnt lgkmcnt(2)
  buffer_store_dwordx4 v[108:111], v95, s[20:23], s33 offen offset:128
  s_cmp_ge_u32 s3, 4
  s_cbranch_scc1 L_k1_end
  s_waitcnt lgkmcnt(0)
  v_readfirstlane_b32 s94, v10
  v_lshrrev_b32 v12, 4, v12
  s_mul_i32 s95, s2, 1152
  s_cmp_gt_u32 s94, 0x427f
  s_cselect_b32 s94, 0x10000, 0
  s_add_u32 s95, s95, 0x2300000
  v_or_b32 v12, s94, v12
  s_lshl_b32 s93, s2, 3
  s_add_u32 s93, s93, 0x2400000
  buffer_store_dword v12, v3, s[24:27], s95 offen
  v_cmp_eq_u32 vcc, 0, v0
  s_mov_b64 exec, vcc
  buffer_store_dwordx2 v[8:9], v5, s[24:27], s93 offen
L_k1_end:
L_k1_exit:
  s_endpgm

.globl gather_scatter__molecular_angular_gemnet__graph_kernel
.p2align 8
.type gather_scatter__molecular_angular_gemnet__graph_kernel,@function
gather_scatter__molecular_angular_gemnet__graph_kernel:
  s_cmp_ge_u32 s2, 256
  s_cbranch_scc1 L_k2_exit
  s_load_dwordx2 s[28:29], s[0:1], 104
  s_load_dwordx16 s[8:23], s[0:1], 40
  s_load_dwordx2 s[24:25], s[0:1], 0
  s_load_dwordx2 s[26:27], s[0:1], 24
  s_and_b32 s3, s2, 7
  s_lshl_b32 s3, s3, 5
  s_lshr_b32 s30, s2, 3
  s_add_u32 s3, s3, s30
  v_lshrrev_b32 v90, 6, v0
  v_and_b32 v2, 63, v0
  v_and_b32 v87, 15, v0
  v_readfirstlane_b32 s30, v90
  v_lshrrev_b32 v86, 4, v2
  v_lshlrev_b32 v87, 4, v87
  v_lshl_or_b32 v86, v86, 16, v87
  v_mul_u32_u24 v87, 1152, v2
  v_mov_b32 v34, 0
  v_lshlrev_b32 v88, 5, v2
  s_lshl_b32 s100, s30, 20
  s_lshl_b32 s101, s3, 8
  s_add_u32 s100, s100, s101
  s_mul_i32 s101, s30, 18432
  s_lshl_b32 s31, s3, 2
  s_add_u32 s101, s101, s31
  s_add_u32 s101, s101, 0x2300000
  s_mov_b32 s31, 0
  s_waitcnt lgkmcnt(0)
  s_mov_b32 s4, s28
  s_mov_b32 s5, s29
  s_mov_b32 s6, 0x4000000
  s_mov_b32 s7, 0x20000
  s_cmp_lg_u32 s30, 15
  s_cbranch_scc1 L_k2_nost0
  s_mov_b32 s28, 0x2400000
  buffer_load_dwordx4 v[94:97], v88, s[4:7], s28 offen
  buffer_load_dwordx4 v[98:101], v88, s[4:7], s28 offen offset:16
L_k2_nost0:
  s_mov_b64 exec, 0xffff
  buffer_load_dword v34, v87, s[4:7], s101 offen
  s_mov_b64 exec, -1
  buffer_load_dwordx4 v[4:7], v86, s[4:7], s100 offen
  s_add_u32 s100, s100, 262144
  buffer_load_dwordx4 v[8:11], v86, s[4:7], s100 offen
  s_add_u32 s100, s100, 262144
  buffer_load_dwordx4 v[12:15], v86, s[4:7], s100 offen
  s_add_u32 s100, s100, 262144
  buffer_load_dwordx4 v[16:19], v86, s[4:7], s100 offen
  s_cmp_ge_u32 s30, 10
  s_cbranch_scc1 L_k2_nosc
  s_load_dwordx16 s[32:47], s[14:15], 0
  s_load_dwordx16 s[48:63], s[14:15], 64
  s_load_dwordx16 s[64:79], s[14:15], 128
  s_load_dwordx16 s[80:95], s[12:13], 0
  s_load_dwordx4 s[96:99], s[8:9], 0
L_k2_nosc:
  v_mov_b32 v102, 0
  v_mov_b32 v103, 0
  v_mov_b32 v104, 0
  v_mov_b32 v105, 0
  v_lshlrev_b32 v91, 4, v0
  s_cmp_ge_u32 s30, 4
  s_cbranch_scc1 L_k2_nocnt
  v_mul_u32_u24 v92, 516, v0
  v_cmp_gt_u32 vcc, 160, v0
  v_add_u32 v92, 31744, v92
  v_lshlrev_b32 v93, 2, v0
  s_nop 0
  v_cndmask_b32 v92, 0, v92, vcc
  ds_write_b32 v93, v92 offset:30720
L_k2_nocnt:
  ds_write_b128 v91, v[102:105]
  s_cmp_ge_u32 s30, 14
  s_cbranch_scc1 L_k2_noz
  ds_write_b128 v91, v[102:105] offset:16384
L_k2_noz:
  v_lshlrev_b32 v1, 3, v0
  v_mov_b32 v69, 0
  v_mov_b32 v35, 4
  v_mov_b32 v110, 0x6050400
  v_mov_b32 v111, 0x6050401
  v_mov_b32 v112, 0x6050402
  s_waitcnt lgkmcnt(0)
  s_barrier
  s_waitcnt vmcnt(3)
  v_cmpx_ne_u32 s[8:9], -1, v4
  v_lshlrev_b32_sdwa v20, 2, v4 dst_sel:DWORD dst_unused:UNUSED_PAD src0_sel:DWORD src1_sel:BYTE_3
  v_perm_b32 v4, v4, v7, v110
  ds_add_rtn_u32 v20, v20, v35 offset:30720
  s_mov_b64 exec, -1
  v_cmpx_ne_u32 s[10:11], -1, v5
  v_lshlrev_b32_sdwa v21, 2, v5 dst_sel:DWORD dst_unused:UNUSED_PAD src0_sel:DWORD src1_sel:BYTE_3
  v_perm_b32 v5, v5, v7, v111
  ds_add_rtn_u32 v21, v21, v35 offset:30720
  s_mov_b64 exec, -1
  v_cmpx_ne_u32 s[12:13], -1, v6
  v_lshlrev_b32_sdwa v22, 2, v6 dst_sel:DWORD dst_unused:UNUSED_PAD src0_sel:DWORD src1_sel:BYTE_3
  v_perm_b32 v6, v6, v7, v112
  ds_add_rtn_u32 v22, v22, v35 offset:30720
  s_mov_b64 exec, -1
  s_waitcnt vmcnt(2)
  v_cmpx_ne_u32 s[14:15], -1, v8
  v_lshlrev_b32_sdwa v23, 2, v8 dst_sel:DWORD dst_unused:UNUSED_PAD src0_sel:DWORD src1_sel:BYTE_3
  v_perm_b32 v8, v8, v11, v110
  ds_add_rtn_u32 v23, v23, v35 offset:30720
  s_mov_b64 exec, -1
  v_cmpx_ne_u32 s[28:29], -1, v9
  v_lshlrev_b32_sdwa v24, 2, v9 dst_sel:DWORD dst_unused:UNUSED_PAD src0_sel:DWORD src1_sel:BYTE_3
  v_perm_b32 v9, v9, v11, v111
  ds_add_rtn_u32 v24, v24, v35 offset:30720
  s_mov_b64 exec, -1
  v_cmpx_ne_u32 s[100:101], -1, v10
  v_lshlrev_b32_sdwa v25, 2, v10 dst_sel:DWORD dst_unused:UNUSED_PAD src0_sel:DWORD src1_sel:BYTE_3
  v_perm_b32 v10, v10, v11, v112
  ds_add_rtn_u32 v25, v25, v35 offset:30720
  s_mov_b64 exec, -1
  s_waitcnt lgkmcnt(3)
  s_mov_b64 exec, s[8:9]
  ds_write_b32 v20, v4
  s_mov_b64 exec, s[10:11]
  ds_write_b32 v21, v5
  s_mov_b64 exec, s[12:13]
  ds_write_b32 v22, v6
  s_mov_b64 exec, -1
  s_waitcnt vmcnt(1)
  v_cmpx_ne_u32 s[8:9], -1, v12
  v_lshlrev_b32_sdwa v26, 2, v12 dst_sel:DWORD dst_unused:UNUSED_PAD src0_sel:DWORD src1_sel:BYTE_3
  v_perm_b32 v12, v12, v15, v110
  ds_add_rtn_u32 v26, v26, v35 offset:30720
  s_mov_b64 exec, -1
  v_cmpx_ne_u32 s[10:11], -1, v13
  v_lshlrev_b32_sdwa v27, 2, v13 dst_sel:DWORD dst_unused:UNUSED_PAD src0_sel:DWORD src1_sel:BYTE_3
  v_perm_b32 v13, v13, v15, v111
  ds_add_rtn_u32 v27, v27, v35 offset:30720
  s_mov_b64 exec, -1
  v_cmpx_ne_u32 s[12:13], -1, v14
  v_lshlrev_b32_sdwa v28, 2, v14 dst_sel:DWORD dst_unused:UNUSED_PAD src0_sel:DWORD src1_sel:BYTE_3
  v_perm_b32 v14, v14, v15, v112
  ds_add_rtn_u32 v28, v28, v35 offset:30720
  s_mov_b64 exec, -1
  s_waitcnt lgkmcnt(6)
  s_mov_b64 exec, s[14:15]
  ds_write_b32 v23, v8
  s_mov_b64 exec, s[28:29]
  ds_write_b32 v24, v9
  s_mov_b64 exec, s[100:101]
  ds_write_b32 v25, v10
  s_mov_b64 exec, -1
  s_waitcnt vmcnt(0)
  v_cmpx_ne_u32 s[14:15], -1, v16
  v_lshlrev_b32_sdwa v29, 2, v16 dst_sel:DWORD dst_unused:UNUSED_PAD src0_sel:DWORD src1_sel:BYTE_3
  v_perm_b32 v16, v16, v19, v110
  ds_add_rtn_u32 v29, v29, v35 offset:30720
  s_mov_b64 exec, -1
  v_cmpx_ne_u32 s[28:29], -1, v17
  v_lshlrev_b32_sdwa v30, 2, v17 dst_sel:DWORD dst_unused:UNUSED_PAD src0_sel:DWORD src1_sel:BYTE_3
  v_perm_b32 v17, v17, v19, v111
  ds_add_rtn_u32 v30, v30, v35 offset:30720
  s_mov_b64 exec, -1
  v_cmpx_ne_u32 s[100:101], -1, v18
  v_lshlrev_b32_sdwa v31, 2, v18 dst_sel:DWORD dst_unused:UNUSED_PAD src0_sel:DWORD src1_sel:BYTE_3
  v_perm_b32 v18, v18, v19, v112
  ds_add_rtn_u32 v31, v31, v35 offset:30720
  s_mov_b64 exec, -1
  s_waitcnt lgkmcnt(6)
  s_mov_b64 exec, s[8:9]
  ds_write_b32 v26, v12
  s_mov_b64 exec, s[10:11]
  ds_write_b32 v27, v13
  s_mov_b64 exec, s[12:13]
  ds_write_b32 v28, v14
  s_mov_b64 exec, -1
  s_cmp_lg_u32 s30, 15
  s_cbranch_scc1 L_k2_nost1
  v_max3_u32 v94, v94, v96, v98
  v_add_f32 v95, v95, v97
  v_add_f32 v99, v99, v101
  v_max_u32 v94, v94, v100
  v_add_f32 v95, v95, v99
  s_nop 1
  s_nop 0
  v_max_u32_dpp v94, v94, v94 row_shr:1 row_mask:0xf bank_mask:0xf bound_ctrl:0
  v_add_f32_dpp v95, v95, v95 row_shr:1 row_mask:0xf bank_mask:0xf bound_ctrl:0
  s_nop 0
  v_max_u32_dpp v94, v94, v94 row_shr:2 row_mask:0xf bank_mask:0xf bound_ctrl:0
  v_add_f32_dpp v95, v95, v95 row_shr:2 row_mask:0xf bank_mask:0xf bound_ctrl:0
  s_nop 0
  v_max_u32_dpp v94, v94, v94 row_shr:4 row_mask:0xf bank_mask:0xf bound_ctrl:0
  v_add_f32_dpp v95, v95, v95 row_shr:4 row_mask:0xf bank_mask:0xf bound_ctrl:0
  s_nop 0
  v_max_u32_dpp v94, v94, v94 row_shr:8 row_mask:0xf bank_mask:0xf bound_ctrl:0
  v_add_f32_dpp v95, v95, v95 row_shr:8 row_mask:0xf bank_mask:0xf bound_ctrl:0
  s_nop 0
  v_max_u32_dpp v94, v94, v94 row_bcast:15 row_mask:0xa bank_mask:0xf
  v_add_f32_dpp v95, v95, v95 row_bcast:15 row_mask:0xa bank_mask:0xf
  s_nop 0
  v_max_u32_dpp v94, v94, v94 row_bcast:31 row_mask:0xc bank_mask:0xf
  v_add_f32_dpp v95, v95, v95 row_bcast:31 row_mask:0xc bank_mask:0xf
  s_mov_b32 exec_lo, 0
  s_mov_b32 exec_hi, 0x80000000
  ds_write_b64 v69, v[94:95] offset:31616
  s_mov_b64 exec, -1
L_k2_nost1:
  s_waitcnt lgkmcnt(3)
  s_mov_b64 exec, s[14:15]
  ds_write_b32 v29, v16
  s_mov_b64 exec, s[28:29]
  ds_write_b32 v30, v17
  s_mov_b64 exec, s[100:101]
  ds_write_b32 v31, v18
  s_mov_b64 exec, -1
  v_subrev_u32 v94, 24, v34
  v_cmp_lt_u32 vcc, 56, v34
  v_med3_i32 v94, v94, 0, 32
  v_lshlrev_b32 v95, 3, v2
  s_mov_b64 s[100:101], 0
  v_cmp_lt_u32 s[12:13], 0, v94
  v_mov_b32 v23, 0
  s_mul_i32 s28, s30, 1052672
  s_lshl_b32 s29, s3, 8
  s_add_u32 s28, s28, s29
  s_add_u32 s28, s28, 0x1100000
  s_mov_b32 s14, 0
  s_cbranch_vccnz L_k2_flag
L_k2_rl:
  s_cmp_eq_u64 s[12:13], 0
  s_cbranch_scc1 L_k2_rldone
  s_ff1_i32_b64 s15, s[12:13]
  s_bitset0_b64 s[12:13], s15
  v_readlane_b32 s29, v94, s15
  s_mul_i32 s15, s15, 65792
  s_add_u32 s15, s15, s28
  s_lshl_b32 s10, s14, 3
  s_sub_u32 s15, s15, s10
  s_bfm_b64 s[10:11], s29, s14
  s_add_u32 s14, s14, s29
  s_cmp_gt_u32 s14, 64
  s_cbranch_scc1 L_k2_flag
  s_or_b64 s[100:101], s[100:101], s[10:11]
  s_mov_b64 exec, s[10:11]
  v_add_u32 v23, s15, v95
  s_mov_b64 exec, -1
  s_branch L_k2_rl
L_k2_flag:
  v_mov_b32 v96, 1
  ds_write_b32 v69, v96 offset:31624
  s_mov_b64 s[100:101], 0
L_k2_rldone:
  s_mov_b64 exec, s[100:101]
  buffer_load_dwordx2 v[32:33], v23, s[4:7], 0 offen
  s_mov_b64 exec, -1
  s_cmp_gt_u32 s30, 9
  s_cbranch_scc1 L_k2_nosmall
  s_mul_i32 s28, s3, 625
  v_min_u32 v103, 624, v0
  v_and_b32 v102, 7, v0
  v_add_u32 v103, s28, v103
  v_lshlrev_b32 v102, 2, v102
  v_lshlrev_b32 v104, 3, v103
  v_lshlrev_b32 v103, 1, v103
  global_load_dword v67, v102, s[16:17]
  global_load_dword v68, v102, s[18:19]
  global_load_ushort v66, v103, s[26:27]
  global_load_dwordx2 v[64:65], v104, s[24:25]
L_k2_nosmall:
  s_mov_b32 s8, s24
  s_mov_b32 s9, s25
  s_mov_b32 s10, 0x138800
  s_mov_b32 s11, 0x20000
  s_mul_i32 s28, s3, 5000
  s_add_u32 s20, s20, s28
  s_addc_u32 s21, s21, 0
  s_mov_b32 s22, 0x1388
  s_mov_b32 s23, 0x20000
  s_mul_i32 s28, s30, 5160
  s_add_u32 s28, s28, 31744
  v_lshlrev_b32 v20, 2, v2
  v_mul_u32_u24 v21, 516, v2
  s_mul_i32 s29, s30, 40
  v_add_u32 v106, s28, v20
  s_add_u32 s29, s29, 30720
  v_add_u32 v21, s28, v21
  v_add_u32 v107, 2064, v106
  v_add_u32 v108, 4128, v106
  v_add_u32 v22, s29, v20
  s_mul_i32 s13, s30, 81920
  s_mov_b32 s12, 0x1ff8
  s_add_u32 s15, s28, 256
  s_waitcnt lgkmcnt(0)
  s_barrier
  s_cmp_lt_u32 s30, 10
  s_cbranch_scc1 L_k2_noprio
  s_setprio 3
L_k2_noprio:
  ds_read_b32 v22, v22
  ds_read2_b32 v[4:5], v106 offset0:0 offset1:129
  ds_read_b32 v6, v106 offset:1032
  ds_read_b32 v7, v106 offset:1548
  ds_read_b32 v114, v20 offset:30720
  ds_read_b32 v115, v20 offset:30976
  ds_read_b32 v116, v20 offset:31232
  ds_read_b96 v[24:26], v69 offset:31616
  ds_read2_b32 v[8:9], v107 offset0:0 offset1:129
  ds_read_b32 v10, v107 offset:1032
  ds_read_b32 v11, v107 offset:1548
  ds_read2_b32 v[12:13], v108 offset0:0 offset1:129
  s_waitcnt lgkmcnt(11)
  v_sub_u32 v22, v22, v21
  v_lshrrev_b32 v22, 2, v22
  s_nop 0
  v_readlane_b32 s28, v22, 0
  s_bfm_b64 s[16:17], s28, 0
  s_cmp_ge_u32 s28, 64
  s_cselect_b64 s[16:17], -1, s[16:17]
  s_waitcnt lgkmcnt(10)
  v_lshrrev_b32 v86, 19, v4
  s_add_u32 s29, s13, 0
  v_and_b32 v86, 0x1ff8, v86
  s_mov_b64 exec, s[16:17]
  buffer_load_dwordx2 v[36:37], v86, s[8:11], s29 offen
  s_mov_b64 exec, -1
  v_readlane_b32 s28, v22, 1
  s_bfm_b64 s[18:19], s28, 0
  s_cmp_ge_u32 s28, 64
  s_cselect_b64 s[18:19], -1, s[18:19]
  v_lshrrev_b32 v87, 19, v5
  s_add_u32 s29, s13, 8192
  v_and_b32 v87, 0x1ff8, v87
  s_mov_b64 exec, s[18:19]
  buffer_load_dwordx2 v[38:39], v87, s[8:11], s29 offen
  s_mov_b64 exec, -1
  v_readlane_b32 s28, v22, 2
  s_bfm_b64 s[24:25], s28, 0
  s_cmp_ge_u32 s28, 64
  s_cselect_b64 s[24:25], -1, s[24:25]
  s_waitcnt lgkmcnt(8)
  v_lshrrev_b32 v88, 19, v6
  s_add_u32 s29, s13, 16384
  v_and_b32 v88, 0x1ff8, v88
  s_mov_b64 exec, s[24:25]
  buffer_load_dwordx2 v[40:41], v88, s[8:11], s29 offen
  s_mov_b64 exec, -1
  v_readlane_b32 s28, v22, 3
  s_bfm_b64 s[26:27], s28, 0
  s_cmp_ge_u32 s28, 64
  s_cselect_b64 s[26:27], -1, s[26:27]
  v_lshrrev_b32 v89, 19, v7
  s_add_u32 s29, s13, 24576
  v_and_b32 v89, 0x1ff8, v89
  s_mov_b64 exec, s[26:27]
  buffer_load_dwordx2 v[42:43], v89, s[8:11], s29 offen
  s_mov_b64 exec, -1
  s_waitcnt vmcnt(4)
  s_waitcnt lgkmcnt(0)
  s_cmp_gt_u32 s30, 9
  s_cbranch_scc1 L_k2_nopro
  v_lshlrev_b32 v66, 16, v66
  s_lshl_b32 s28, s96, 16
  s_and_b32 s29, s96, 0xffff0000
  v_subrev_f32 v94, s28, v66
  v_subrev_f32 v95, s29, v66
  s_lshl_b32 s28, s97, 16
  s_and_b32 s29, s97, 0xffff0000
  v_subrev_f32 v96, s28, v66
  v_subrev_f32 v97, s29, v66
  s_lshl_b32 s28, s98, 16
  s_and_b32 s29, s98, 0xffff0000
  v_subrev_f32 v98, s28, v66
  v_subrev_f32 v99, s29, v66
  s_lshl_b32 s28, s99, 16
  s_and_b32 s29, s99, 0xffff0000
  v_subrev_f32 v100, s28, v66
  v_subrev_f32 v101, s29, v66
  v_cvt_pk_bf16_f32 v102, v94, v95
  v_cvt_pk_bf16_f32 v103, v96, v97
  v_cvt_pk_bf16_f32 v104, v98, v99
  v_cvt_pk_bf16_f32 v105, v100, v101
  v_lshlrev_b32 v94, 16, v102
  v_and_b32 v95, 0xffff0000, v102
  v_lshlrev_b32 v96, 16, v103
  v_and_b32 v97, 0xffff0000, v103
  v_lshlrev_b32 v98, 16, v104
  v_and_b32 v99, 0xffff0000, v104
  v_lshlrev_b32 v100, 16, v105
  v_and_b32 v101, 0xffff0000, v105
  v_mul_f32 v94, v94, v94
  v_mul_f32 v95, v95, v95
  v_mul_f32 v96, v96, v96
  v_mul_f32 v97, v97, v97
  v_mul_f32 v98, v98, v98
  v_mul_f32 v99, v99, v99
  v_mul_f32 v100, v100, v100
  v_mul_f32 v101, v101, v101
  v_cvt_pk_bf16_f32 v102, v94, v95
  v_cvt_pk_bf16_f32 v103, v96, v97
  v_cvt_pk_bf16_f32 v104, v98, v99
  v_cvt_pk_bf16_f32 v105, v100, v101
  v_lshlrev_b32 v94, 16, v102
  v_and_b32 v95, 0xffff0000, v102
  v_lshlrev_b32 v96, 16, v103
  v_and_b32 v97, 0xffff0000, v103
  v_lshlrev_b32 v98, 16, v104
  v_and_b32 v99, 0xffff0000, v104
  v_lshlrev_b32 v100, 16, v105
  v_and_b32 v101, 0xffff0000, v105
  v_mul_f32 v94, 0xc1200000, v94
  v_mul_f32 v95, 0xc1200000, v95
  v_mul_f32 v96, 0xc1200000, v96
  v_mul_f32 v97, 0xc1200000, v97
  v_mul_f32 v98, 0xc1200000, v98
  v_mul_f32 v99, 0xc1200000, v99
  v_mul_f32 v100, 0xc1200000, v100
  v_mul_f32 v101, 0xc1200000, v101
  v_cvt_pk_bf16_f32 v102, v94, v95
  v_cvt_pk_bf16_f32 v103, v96, v97
  v_cvt_pk_bf16_f32 v104, v98, v99
  v_cvt_pk_bf16_f32 v105, v100, v101
  v_lshlrev_b32 v94, 16, v102
  v_and_b32 v95, 0xffff0000, v102
  v_lshlrev_b32 v96, 16, v103
  v_and_b32 v97, 0xffff0000, v103
  v_lshlrev_b32 v98, 16, v104
  v_and_b32 v99, 0xffff0000, v104
  v_lshlrev_b32 v100, 16, v105
  v_and_b32 v101, 0xffff0000, v105
  v_mul_f32 v94, 0x3fb8aa3b, v94
  v_mul_f32 v95, 0x3fb8aa3b, v95
  v_mul_f32 v96, 0x3fb8aa3b, v96
  v_mul_f32 v97, 0x3fb8aa3b, v97
  v_mul_f32 v98, 0x3fb8aa3b, v98
  v_mul_f32 v99, 0x3fb8aa3b, v99
  v_mul_f32 v100, 0x3fb8aa3b, v100
  v_mul_f32 v101, 0x3fb8aa3b, v101
  v_exp_f32 v94, v94
  v_exp_f32 v95, v95
  v_exp_f32 v96, v96
  v_exp_f32 v97, v97
  v_exp_f32 v98, v98
  v_exp_f32 v99, v99
  v_exp_f32 v100, v100
  v_exp_f32 v101, v101
  s_nop 0
  v_cvt_pk_bf16_f32 v102, v94, v95
  v_cvt_pk_bf16_f32 v103, v96, v97
  v_cvt_pk_bf16_f32 v104, v98, v99
  v_cvt_pk_bf16_f32 v105, v100, v101
  v_lshlrev_b32 v94, 16, v102
  v_and_b32 v95, 0xffff0000, v102
  v_lshlrev_b32 v96, 16, v103
  v_and_b32 v97, 0xffff0000, v103
  v_lshlrev_b32 v98, 16, v104
  v_and_b32 v99, 0xffff0000, v104
  v_lshlrev_b32 v100, 16, v105
  v_and_b32 v101, 0xffff0000, v105
  s_lshl_b32 s28, s32, 16
  s_and_b32 s29, s32, 0xffff0000
  v_pk_mul_f32 v[48:49], v[94:95], s[28:29] op_sel:[0,0] op_sel_hi:[0,1]
  s_lshl_b32 s28, s33, 16
  s_and_b32 s29, s33, 0xffff0000
  v_pk_mul_f32 v[50:51], v[94:95], s[28:29] op_sel:[0,0] op_sel_hi:[0,1]
  s_lshl_b32 s28, s34, 16
  s_and_b32 s29, s34, 0xffff0000
  v_pk_mul_f32 v[52:53], v[94:95], s[28:29] op_sel:[0,0] op_sel_hi:[0,1]
  s_lshl_b32 s28, s35, 16
  s_and_b32 s29, s35, 0xffff0000
  v_pk_mul_f32 v[54:55], v[94:95], s[28:29] op_sel:[0,0] op_sel_hi:[0,1]
  s_lshl_b32 s28, s36, 16
  s_and_b32 s29, s36, 0xffff0000
  v_pk_mul_f32 v[56:57], v[94:95], s[28:29] op_sel:[0,0] op_sel_hi:[0,1]
  s_lshl_b32 s28, s37, 16
  s_and_b32 s29, s37, 0xffff0000
  v_pk_mul_f32 v[58:59], v[94:95], s[28:29] op_sel:[0,0] op_sel_hi:[0,1]
  s_lshl_b32 s28, s80, 16
  s_and_b32 s29, s80, 0xffff0000
  v_pk_mul_f32 v[60:61], v[94:95], s[28:29] op_sel:[0,0] op_sel_hi:[0,1]
  s_lshl_b32 s28, s81, 16
  s_and_b32 s29, s81, 0xffff0000
  v_pk_mul_f32 v[62:63], v[94:95], s[28:29] op_sel:[0,0] op_sel_hi:[0,1]
  s_lshl_b32 s28, s38, 16
  s_and_b32 s29, s38, 0xffff0000
  v_pk_fma_f32 v[48:49], v[94:95], s[28:29], v[48:49] op_sel:[1,0,0] op_sel_hi:[1,1,1]
  s_lshl_b32 s28, s39, 16
  s_and_b32 s29, s39, 0xffff0000
  v_pk_fma_f32 v[50:51], v[94:95], s[28:29], v[50:51] op_sel:[1,0,0] op_sel_hi:[1,1,1]
  s_lshl_b32 s28, s40, 16
  s_and_b32 s29, s40, 0xffff0000
  v_pk_fma_f32 v[52:53], v[94:95], s[28:29], v[52:53] op_sel:[1,0,0] op_sel_hi:[1,1,1]
  s_lshl_b32 s28, s41, 16
  s_and_b32 s29, s41, 0xffff0000
  v_pk_fma_f32 v[54:55], v[94:95], s[28:29], v[54:55] op_sel:[1,0,0] op_sel_hi:[1,1,1]
  s_lshl_b32 s28, s42, 16
  s_and_b32 s29, s42, 0xffff0000
  v_pk_fma_f32 v[56:57], v[94:95], s[28:29], v[56:57] op_sel:[1,0,0] op_sel_hi:[1,1,1]
  s_lshl_b32 s28, s43, 16
  s_and_b32 s29, s43, 0xffff0000
  v_pk_fma_f32 v[58:59], v[94:95], s[28:29], v[58:59] op_sel:[1,0,0] op_sel_hi:[1,1,1]
  s_lshl_b32 s28, s82, 16
  s_and_b32 s29, s82, 0xffff0000
  v_pk_fma_f32 v[60:61], v[94:95], s[28:29], v[60:61] op_sel:[1,0,0] op_sel_hi:[1,1,1]
  s_lshl_b32 s28, s83, 16
  s_and_b32 s29, s83, 0xffff0000
  v_pk_fma_f32 v[62:63], v[94:95], s[28:29], v[62:63] op_sel:[1,0,0] op_sel_hi:[1,1,1]
  s_lshl_b32 s28, s44, 16
  s_and_b32 s29, s44, 0xffff0000
  v_pk_fma_f32 v[48:49], v[96:97], s[28:29], v[48:49] op_sel:[0,0,0] op_sel_hi:[0,1,1]
  s_lshl_b32 s28, s45, 16
  s_and_b32 s29, s45, 0xffff0000
  v_pk_fma_f32 v[50:51], v[96:97], s[28:29], v[50:51] op_sel:[0,0,0] op_sel_hi:[0,1,1]
  s_lshl_b32 s28, s46, 16
  s_and_b32 s29, s46, 0xffff0000
  v_pk_fma_f32 v[52:53], v[96:97], s[28:29], v[52:53] op_sel:[0,0,0] op_sel_hi:[0,1,1]
  s_lshl_b32 s28, s47, 16
  s_and_b32 s29, s47, 0xffff0000
  v_pk_fma_f32 v[54:55], v[96:97], s[28:29], v[54:55] op_sel:[0,0,0] op_sel_hi:[0,1,1]
  s_lshl_b32 s28, s48, 16
  s_and_b32 s29, s48, 0xffff0000
  v_pk_fma_f32 v[56:57], v[96:97], s[28:29], v[56:57] op_sel:[0,0,0] op_sel_hi:[0,1,1]
  s_lshl_b32 s28, s49, 16
  s_and_b32 s29, s49, 0xffff0000
  v_pk_fma_f32 v[58:59], v[96:97], s[28:29], v[58:59] op_sel:[0,0,0] op_sel_hi:[0,1,1]
  s_lshl_b32 s28, s84, 16
  s_and_b32 s29, s84, 0xffff0000
  v_pk_fma_f32 v[60:61], v[96:97], s[28:29], v[60:61] op_sel:[0,0,0] op_sel_hi:[0,1,1]
  s_lshl_b32 s28, s85, 16
  s_and_b32 s29, s85, 0xffff0000
  v_pk_fma_f32 v[62:63], v[96:97], s[28:29], v[62:63] op_sel:[0,0,0] op_sel_hi:[0,1,1]
  s_lshl_b32 s28, s50, 16
  s_and_b32 s29, s50, 0xffff0000
  v_pk_fma_f32 v[48:49], v[96:97], s[28:29], v[48:49] op_sel:[1,0,0] op_sel_hi:[1,1,1]
  s_lshl_b32 s28, s51, 16
  s_and_b32 s29, s51, 0xffff0000
  v_pk_fma_f32 v[50:51], v[96:97], s[28:29], v[50:51] op_sel:[1,0,0] op_sel_hi:[1,1,1]
  s_lshl_b32 s28, s52, 16
  s_and_b32 s29, s52, 0xffff0000
  v_pk_fma_f32 v[52:53], v[96:97], s[28:29], v[52:53] op_sel:[1,0,0] op_sel_hi:[1,1,1]
  s_lshl_b32 s28, s53, 16
  s_and_b32 s29, s53, 0xffff0000
  v_pk_fma_f32 v[54:55], v[96:97], s[28:29], v[54:55] op_sel:[1,0,0] op_sel_hi:[1,1,1]
  s_lshl_b32 s28, s54, 16
  s_and_b32 s29, s54, 0xffff0000
  v_pk_fma_f32 v[56:57], v[96:97], s[28:29], v[56:57] op_sel:[1,0,0] op_sel_hi:[1,1,1]
  s_lshl_b32 s28, s55, 16
  s_and_b32 s29, s55, 0xffff0000
  v_pk_fma_f32 v[58:59], v[96:97], s[28:29], v[58:59] op_sel:[1,0,0] op_sel_hi:[1,1,1]
  s_lshl_b32 s28, s86, 16
  s_and_b32 s29, s86, 0xffff0000
  v_pk_fma_f32 v[60:61], v[96:97], s[28:29], v[60:61] op_sel:[1,0,0] op_sel_hi:[1,1,1]
  s_lshl_b32 s28, s87, 16
  s_and_b32 s29, s87, 0xffff0000
  v_pk_fma_f32 v[62:63], v[96:97], s[28:29], v[62:63] op_sel:[1,0,0] op_sel_hi:[1,1,1]
  s_lshl_b32 s28, s56, 16
  s_and_b32 s29, s56, 0xffff0000
  v_pk_fma_f32 v[48:49], v[98:99], s[28:29], v[48:49] op_sel:[0,0,0] op_sel_hi:[0,1,1]
  s_lshl_b32 s28, s57, 16
  s_and_b32 s29, s57, 0xffff0000
  v_pk_fma_f32 v[50:51], v[98:99], s[28:29], v[50:51] op_sel:[0,0,0] op_sel_hi:[0,1,1]
  s_lshl_b32 s28, s58, 16
  s_and_b32 s29, s58, 0xffff0000
  v_pk_fma_f32 v[52:53], v[98:99], s[28:29], v[52:53] op_sel:[0,0,0] op_sel_hi:[0,1,1]
  s_lshl_b32 s28, s59, 16
  s_and_b32 s29, s59, 0xffff0000
  v_pk_fma_f32 v[54:55], v[98:99], s[28:29], v[54:55] op_sel:[0,0,0] op_sel_hi:[0,1,1]
  s_lshl_b32 s28, s60, 16
  s_and_b32 s29, s60, 0xffff0000
  v_pk_fma_f32 v[56:57], v[98:99], s[28:29], v[56:57] op_sel:[0,0,0] op_sel_hi:[0,1,1]
  s_lshl_b32 s28, s61, 16
  s_and_b32 s29, s61, 0xffff0000
  v_pk_fma_f32 v[58:59], v[98:99], s[28:29], v[58:59] op_sel:[0,0,0] op_sel_hi:[0,1,1]
  s_lshl_b32 s28, s88, 16
  s_and_b32 s29, s88, 0xffff0000
  v_pk_fma_f32 v[60:61], v[98:99], s[28:29], v[60:61] op_sel:[0,0,0] op_sel_hi:[0,1,1]
  s_lshl_b32 s28, s89, 16
  s_and_b32 s29, s89, 0xffff0000
  v_pk_fma_f32 v[62:63], v[98:99], s[28:29], v[62:63] op_sel:[0,0,0] op_sel_hi:[0,1,1]
  s_lshl_b32 s28, s62, 16
  s_and_b32 s29, s62, 0xffff0000
  v_pk_fma_f32 v[48:49], v[98:99], s[28:29], v[48:49] op_sel:[1,0,0] op_sel_hi:[1,1,1]
  s_lshl_b32 s28, s63, 16
  s_and_b32 s29, s63, 0xffff0000
  v_pk_fma_f32 v[50:51], v[98:99], s[28:29], v[50:51] op_sel:[1,0,0] op_sel_hi:[1,1,1]
  s_lshl_b32 s28, s64, 16
  s_and_b32 s29, s64, 0xffff0000
  v_pk_fma_f32 v[52:53], v[98:99], s[28:29], v[52:53] op_sel:[1,0,0] op_sel_hi:[1,1,1]
  s_lshl_b32 s28, s65, 16
  s_and_b32 s29, s65, 0xffff0000
  v_pk_fma_f32 v[54:55], v[98:99], s[28:29], v[54:55] op_sel:[1,0,0] op_sel_hi:[1,1,1]
  s_lshl_b32 s28, s66, 16
  s_and_b32 s29, s66, 0xffff0000
  v_pk_fma_f32 v[56:57], v[98:99], s[28:29], v[56:57] op_sel:[1,0,0] op_sel_hi:[1,1,1]
  s_lshl_b32 s28, s67, 16
  s_and_b32 s29, s67, 0xffff0000
  v_pk_fma_f32 v[58:59], v[98:99], s[28:29], v[58:59] op_sel:[1,0,0] op_sel_hi:[1,1,1]
  s_lshl_b32 s28, s90, 16
  s_and_b32 s29, s90, 0xffff0000
  v_pk_fma_f32 v[60:61], v[98:99], s[28:29], v[60:61] op_sel:[1,0,0] op_sel_hi:[1,1,1]
  s_lshl_b32 s28, s91, 16
  s_and_b32 s29, s91, 0xffff0000
  v_pk_fma_f32 v[62:63], v[98:99], s[28:29], v[62:63] op_sel:[1,0,0] op_sel_hi:[1,1,1]
  s_lshl_b32 s28, s68, 16
  s_and_b32 s29, s68, 0xffff0000
  v_pk_fma_f32 v[48:49], v[100:101], s[28:29], v[48:49] op_sel:[0,0,0] op_sel_hi:[0,1,1]
  s_lshl_b32 s28, s69, 16
  s_and_b32 s29, s69, 0xffff0000
  v_pk_fma_f32 v[50:51], v[100:101], s[28:29], v[50:51] op_sel:[0,0,0] op_sel_hi:[0,1,1]
  s_lshl_b32 s28, s70, 16
  s_and_b32 s29, s70, 0xffff0000
  v_pk_fma_f32 v[52:53], v[100:101], s[28:29], v[52:53] op_sel:[0,0,0] op_sel_hi:[0,1,1]
  s_lshl_b32 s28, s71, 16
  s_and_b32 s29, s71, 0xffff0000
  v_pk_fma_f32 v[54:55], v[100:101], s[28:29], v[54:55] op_sel:[0,0,0] op_sel_hi:[0,1,1]
  s_lshl_b32 s28, s72, 16
  s_and_b32 s29, s72, 0xffff0000
  v_pk_fma_f32 v[56:57], v[100:101], s[28:29], v[56:57] op_sel:[0,0,0] op_sel_hi:[0,1,1]
  s_lshl_b32 s28, s73, 16
  s_and_b32 s29, s73, 0xffff0000
  v_pk_fma_f32 v[58:59], v[100:101], s[28:29], v[58:59] op_sel:[0,0,0] op_sel_hi:[0,1,1]
  s_lshl_b32 s28, s92, 16
  s_and_b32 s29, s92, 0xffff0000
  v_pk_fma_f32 v[60:61], v[100:101], s[28:29], v[60:61] op_sel:[0,0,0] op_sel_hi:[0,1,1]
  s_lshl_b32 s28, s93, 16
  s_and_b32 s29, s93, 0xffff0000
  v_pk_fma_f32 v[62:63], v[100:101], s[28:29], v[62:63] op_sel:[0,0,0] op_sel_hi:[0,1,1]
  s_lshl_b32 s28, s74, 16
  s_and_b32 s29, s74, 0xffff0000
  v_pk_fma_f32 v[48:49], v[100:101], s[28:29], v[48:49] op_sel:[1,0,0] op_sel_hi:[1,1,1]
  s_lshl_b32 s28, s75, 16
  s_and_b32 s29, s75, 0xffff0000
  v_pk_fma_f32 v[50:51], v[100:101], s[28:29], v[50:51] op_sel:[1,0,0] op_sel_hi:[1,1,1]
  s_lshl_b32 s28, s76, 16
  s_and_b32 s29, s76, 0xffff0000
  v_pk_fma_f32 v[52:53], v[100:101], s[28:29], v[52:53] op_sel:[1,0,0] op_sel_hi:[1,1,1]
  s_lshl_b32 s28, s77, 16
  s_and_b32 s29, s77, 0xffff0000
  v_pk_fma_f32 v[54:55], v[100:101], s[28:29], v[54:55] op_sel:[1,0,0] op_sel_hi:[1,1,1]
  s_lshl_b32 s28, s78, 16
  s_and_b32 s29, s78, 0xffff0000
  v_pk_fma_f32 v[56:57], v[100:101], s[28:29], v[56:57] op_sel:[1,0,0] op_sel_hi:[1,1,1]
  s_lshl_b32 s28, s79, 16
  s_and_b32 s29, s79, 0xffff0000
  v_pk_fma_f32 v[58:59], v[100:101], s[28:29], v[58:59] op_sel:[1,0,0] op_sel_hi:[1,1,1]
  s_lshl_b32 s28, s94, 16
  s_and_b32 s29, s94, 0xffff0000
  v_pk_fma_f32 v[60:61], v[100:101], s[28:29], v[60:61] op_sel:[1,0,0] op_sel_hi:[1,1,1]
  s_lshl_b32 s28, s95, 16
  s_and_b32 s29, s95, 0xffff0000
  v_pk_fma_f32 v[62:63], v[100:101], s[28:29], v[62:63] op_sel:[1,0,0] op_sel_hi:[1,1,1]
  v_readlane_b32 s28, v67, 0
  s_lshl_b32 s48, s28, 16
  s_and_b32 s49, s28, 0xffff0000
  v_readlane_b32 s29, v68, 0
  s_lshl_b32 s64, s29, 16
  s_and_b32 s65, s29, 0xffff0000
  v_readlane_b32 s28, v67, 1
  s_lshl_b32 s50, s28, 16
  s_and_b32 s51, s28, 0xffff0000
  v_readlane_b32 s29, v68, 1
  s_lshl_b32 s66, s29, 16
  s_and_b32 s67, s29, 0xffff0000
  v_readlane_b32 s28, v67, 2
  s_lshl_b32 s52, s28, 16
  s_and_b32 s53, s28, 0xffff0000
  v_readlane_b32 s29, v68, 2
  s_lshl_b32 s68, s29, 16
  s_and_b32 s69, s29, 0xffff0000
  v_readlane_b32 s28, v67, 3
  s_lshl_b32 s54, s28, 16
  s_and_b32 s55, s28, 0xffff0000
  v_readlane_b32 s29, v68, 3
  s_lshl_b32 s70, s29, 16
  s_and_b32 s71, s29, 0xffff0000
  v_readlane_b32 s28, v67, 4
  s_lshl_b32 s56, s28, 16
  s_and_b32 s57, s28, 0xffff0000
  v_readlane_b32 s29, v68, 4
  s_lshl_b32 s72, s29, 16
  s_and_b32 s73, s29, 0xffff0000
  v_readlane_b32 s28, v67, 5
  s_lshl_b32 s58, s28, 16
  s_and_b32 s59, s28, 0xffff0000
  v_readlane_b32 s29, v68, 5
  s_lshl_b32 s74, s29, 16
  s_and_b32 s75, s29, 0xffff0000
  v_readlane_b32 s28, v67, 6
  s_lshl_b32 s60, s28, 16
  s_and_b32 s61, s28, 0xffff0000
  v_readlane_b32 s29, v68, 6
  s_lshl_b32 s76, s29, 16
  s_and_b32 s77, s29, 0xffff0000
  v_readlane_b32 s28, v67, 7
  s_lshl_b32 s62, s28, 16
  s_and_b32 s63, s28, 0xffff0000
  v_readlane_b32 s29, v68, 7
  s_lshl_b32 s78, s29, 16
  s_and_b32 s79, s29, 0xffff0000
L_k2_nopro:
  v_mul_u32_u24 v98, 129, v20
  v_subrev_u32 v115, 33024, v115
  v_subrev_u32 v116, 66048, v116
  v_add_u32 v98, 32252, v98
  v_max3_i32 v114, v114, v115, v116
  v_mov_b32 v101, 0x459c4000
  v_cmp_lt_i32 vcc, v98, v114
  v_readfirstlane_b32 s96, v24
  v_readfirstlane_b32 s97, v25
  v_readfirstlane_b32 s98, v26
  s_cmp_eq_u64 vcc, 0
  s_cselect_b32 s31, 1, 0
  s_lshl_b32 s99, s96, 16
  s_lshr_b32 s96, s96, 7
  v_mul_f32 v101, s99, v101
  s_cmp_eq_u32 s98, 0
  s_cselect_b32 s31, s31, 0
  v_cmp_ge_f32 vcc, s97, v101
  s_cmp_gt_u32 s96, 16
  s_cselect_b32 s31, s31, 0
  s_cmp_lt_u32 s96, 255
  s_cselect_b32 s31, s31, 0
  s_cmp_lg_u64 vcc, 0
  s_cselect_b32 s31, s31, 0
  s_sub_u32 s36, 270, s96
  s_lshl_b32 s36, s36, 23
  s_sub_u32 s40, s96, 16
  s_lshl_b32 s40, s40, 23
  s_mov_b32 s32, 0x4b400000
  s_mov_b32 s33, 0x4b400000
  s_mov_b32 s34, 0xb4c00000
  s_mov_b32 s35, 0xb4bfffff
  s_mov_b32 s42, 0x70a2f983
  s_mov_b32 s43, 0x70a2f983
  s_mov_b32 s44, 0x40400000
  s_mov_b32 s45, 0x40400000
  s_mov_b32 s46, 0xffff0000
  s_mov_b32 s47, 0xfff
  s_mov_b32 s37, s36
  s_xor_b32 s38, s36, 0x80000000
  s_xor_b32 s39, s36, 0x80000000
  s_mov_b32 s41, s40
  s_bitcmp0_b32 s31, 0
  s_cbranch_scc1 L_k2_slow0
  v_subrev_u32 v117, 64, v22
  v_cmp_gt_u32 vcc, 10, v2
  v_cmp_lt_i32 s[96:97], 0, v117
  v_mov_b32 v18, 0
  v_mov_b32 v19, 0
  v_mov_b32 v17, 0
  s_and_b64 s[96:97], s[96:97], vcc
  s_mov_b64 s[92:93], s[100:101]
  s_mov_b64 s[94:95], 0
  v_perm_b32 v14, v32, v33, v110
  v_lshrrev_b32 v16, 11, v32
  v_and_b32 v16, -8, v16
L_k2_xl0:
  s_cmp_eq_u64 s[96:97], 0
  s_cbranch_scc1 L_k2_xdone
  s_ff1_i32_b64 s98, s[96:97]
  v_readlane_b32 s99, v117, s98
  s_mul_i32 s28, s98, 516
  s_add_u32 s28, s28, s15
  s_lshl_b32 s29, s14, 2
  s_sub_u32 s28, s28, s29
  s_lshl_b32 s29, s98, 13
  s_add_u32 s29, s29, s13
  s_bfm_b64 vcc, s99, s14
  s_add_u32 s14, s14, s99
  s_cmp_gt_u32 s14, 64
  s_cbranch_scc1 L_k2_xd0
  s_bitset0_b64 s[96:97], s98
  s_or_b64 s[92:93], s[92:93], vcc
  s_mov_b64 exec, vcc
  v_add_u32 v18, s28, v20
  v_mov_b32 v16, s29
  s_mov_b64 exec, -1
  s_branch L_k2_xl0
L_k2_xd0:
  s_mov_b32 s14, 0
L_k2_xl1:
  s_cmp_eq_u64 s[96:97], 0
  s_cbranch_scc1 L_k2_xdone
  s_ff1_i32_b64 s98, s[96:97]
  v_readlane_b32 s99, v117, s98
  s_mul_i32 s28, s98, 516
  s_add_u32 s28, s28, s15
  s_lshl_b32 s29, s14, 2
  s_sub_u32 s28, s28, s29
  s_lshl_b32 s29, s98, 13
  s_add_u32 s29, s29, s13
  s_bfm_b64 vcc, s99, s14
  s_add_u32 s14, s14, s99
  s_cmp_gt_u32 s14, 64
  s_cbranch_scc1 L_k2_xd1
  s_bitset0_b64 s[96:97], s98
  s_or_b64 s[94:95], s[94:95], vcc
  s_mov_b64 exec, vcc
  v_add_u32 v19, s28, v20
  v_mov_b32 v17, s29
  s_mov_b64 exec, -1
  s_branch L_k2_xl1
L_k2_xd1:
L_k2_xdone:
  s_andn2_b64 exec, s[92:93], s[100:101]
  ds_read_b32 v14, v18
  s_mov_b64 exec, s[94:95]
  ds_read_b32 v15, v19
  s_mov_b64 exec, -1
  v_readlane_b32 s28, v22, 4
  s_bfm_b64 s[80:81], s28, 0
  s_cmp_ge_u32 s28, 64
  s_cselect_b64 s[80:81], -1, s[80:81]
  v_readlane_b32 s28, v22, 5
  s_bfm_b64 s[82:83], s28, 0
  s_cmp_ge_u32 s28, 64
  s_cselect_b64 s[82:83], -1, s[82:83]
  v_readlane_b32 s28, v22, 6
  s_bfm_b64 s[84:85], s28, 0
  s_cmp_ge_u32 s28, 64
  s_cselect_b64 s[84:85], -1, s[84:85]
  v_readlane_b32 s28, v22, 7
  s_bfm_b64 s[86:87], s28, 0
  s_cmp_ge_u32 s28, 64
  s_cselect_b64 s[86:87], -1, s[86:87]
  v_readlane_b32 s28, v22, 8
  s_bfm_b64 s[88:89], s28, 0
  s_cmp_ge_u32 s28, 64
  s_cselect_b64 s[88:89], -1, s[88:89]
  v_readlane_b32 s28, v22, 9
  s_bfm_b64 s[90:91], s28, 0
  s_cmp_ge_u32 s28, 64
  s_cselect_b64 s[90:91], -1, s[90:91]
  s_waitcnt lgkmcnt(0)
  s_andn2_b64 exec, s[92:93], s[100:101]
  v_lshrrev_b32 v18, 19, v14
  v_and_or_b32 v16, v18, s12, v16
  s_mov_b64 exec, s[94:95]
  v_lshrrev_b32 v19, 19, v15
  v_and_or_b32 v17, v19, s12, v17
  s_mov_b64 exec, -1
  s_waitcnt lgkmcnt(0)
  v_and_b32_sdwa v28, s47, v4 dst_sel:WORD_1 dst_unused:UNUSED_PAD src0_sel:DWORD src1_sel:WORD_0
  v_and_b32_sdwa v29, s47, v5 dst_sel:WORD_1 dst_unused:UNUSED_PAD src0_sel:DWORD src1_sel:WORD_0
  s_nop 0
  v_pk_mul_f32 v[92:93], v[28:29], s[44:45]
  v_pk_mul_f32 v[94:95], v[28:29], s[42:43]
  v_cvt_pk_bf16_f32 v106, v92, v93
  v_cos_f32 v96, v94
  v_cos_f32 v97, v95
  v_lshlrev_b32 v92, 16, v106
  v_and_b32 v93, s46, v106
  v_pk_mul_f32 v[100:101], v[96:97], s[36:37]
  v_pk_mul_f32 v[94:95], v[92:93], s[42:43]
  v_pk_add_f32 v[90:91], v[96:97], v[96:97]
  v_cos_f32 v98, v94
  v_cos_f32 v99, v95
  v_pk_fma_f32 v[102:103], v[100:101], v[90:91], s[38:39]
  v_pk_mul_f32 v[104:105], v[98:99], s[36:37]
  v_lshrrev_b32 v86, 19, v8
  s_add_u32 s29, s13, 32768
  v_and_b32 v86, 0x1ff8, v86
  s_mov_b64 exec, s[80:81]
  buffer_load_dwordx2 v[44:45], v86, s[8:11], s29 offen
  s_mov_b64 exec, -1
  v_lshrrev_b32 v107, 9, v4
  s_waitcnt vmcnt(4)
  v_lshlrev_b32 v82, 16, v36
  v_and_b32 v83, s46, v36
  v_lshlrev_b32 v84, 16, v37
  v_and_b32 v85, s46, v37
  v_and_b32 v107, s12, v107
  v_pk_fma_f32 v[70:71], v[82:83], v[100:101], s[32:33] op_sel:[0,0,0] op_sel_hi:[1,0,1]
  v_pk_fma_f32 v[72:73], v[84:85], v[100:101], s[32:33] op_sel:[0,0,0] op_sel_hi:[1,0,1]
  v_pk_fma_f32 v[74:75], v[82:83], v[102:103], s[32:33] op_sel:[0,0,0] op_sel_hi:[1,0,1]
  v_pk_fma_f32 v[76:77], v[84:85], v[102:103], s[32:33] op_sel:[0,0,0] op_sel_hi:[1,0,1]
  v_pk_fma_f32 v[78:79], v[82:83], v[104:105], s[32:33] op_sel:[0,0,0] op_sel_hi:[1,0,1]
  v_pk_fma_f32 v[80:81], v[84:85], v[104:105], s[32:33] op_sel:[0,0,0] op_sel_hi:[1,0,1]
  v_lshl_add_u64 v[70:71], v[70:71], 0, s[34:35]
  v_lshl_add_u64 v[72:73], v[72:73], 0, s[34:35]
  v_lshl_add_u64 v[74:75], v[74:75], 0, s[34:35]
  v_lshl_add_u64 v[76:77], v[76:77], 0, s[34:35]
  v_lshl_add_u64 v[78:79], v[78:79], 0, s[34:35]
  v_lshl_add_u64 v[80:81], v[80:81], 0, s[34:35]
  s_mov_b64 exec, s[16:17]
  ds_add_u64 v107, v[70:71] offset:0
  ds_add_u64 v107, v[72:73] offset:5120
  ds_add_u64 v107, v[74:75] offset:10240
  ds_add_u64 v107, v[76:77] offset:15360
  ds_add_u64 v107, v[78:79] offset:20480
  ds_add_u64 v107, v[80:81] offset:25600
  s_mov_b64 exec, -1
  v_lshrrev_b32 v87, 19, v9
  s_add_u32 s29, s13, 40960
  v_and_b32 v87, 0x1ff8, v87
  s_mov_b64 exec, s[82:83]
  buffer_load_dwordx2 v[46:47], v87, s[8:11], s29 offen
  s_mov_b64 exec, -1
  v_lshrrev_b32 v107, 9, v5
  s_waitcnt vmcnt(4)
  v_lshlrev_b32 v82, 16, v38
  v_and_b32 v83, s46, v38
  v_lshlrev_b32 v84, 16, v39
  v_and_b32 v85, s46, v39
  v_and_b32 v107, s12, v107
  v_pk_fma_f32 v[70:71], v[82:83], v[100:101], s[32:33] op_sel:[0,1,0] op_sel_hi:[1,1,1]
  v_pk_fma_f32 v[72:73], v[84:85], v[100:101], s[32:33] op_sel:[0,1,0] op_sel_hi:[1,1,1]
  v_pk_fma_f32 v[74:75], v[82:83], v[102:103], s[32:33] op_sel:[0,1,0] op_sel_hi:[1,1,1]
  v_pk_fma_f32 v[76:77], v[84:85], v[102:103], s[32:33] op_sel:[0,1,0] op_sel_hi:[1,1,1]
  v_pk_fma_f32 v[78:79], v[82:83], v[104:105], s[32:33] op_sel:[0,1,0] op_sel_hi:[1,1,1]
  v_pk_fma_f32 v[80:81], v[84:85], v[104:105], s[32:33] op_sel:[0,1,0] op_sel_hi:[1,1,1]
  v_lshl_add_u64 v[70:71], v[70:71], 0, s[34:35]
  v_lshl_add_u64 v[72:73], v[72:73], 0, s[34:35]
  v_lshl_add_u64 v[74:75], v[74:75], 0, s[34:35]
  v_lshl_add_u64 v[76:77], v[76:77], 0, s[34:35]
  v_lshl_add_u64 v[78:79], v[78:79], 0, s[34:35]
  v_lshl_add_u64 v[80:81], v[80:81], 0, s[34:35]
  s_mov_b64 exec, s[18:19]
  ds_add_u64 v107, v[70:71] offset:0
  ds_add_u64 v107, v[72:73] offset:5120
  ds_add_u64 v107, v[74:75] offset:10240
  ds_add_u64 v107, v[76:77] offset:15360
  ds_add_u64 v107, v[78:79] offset:20480
  ds_add_u64 v107, v[80:81] offset:25600
  s_mov_b64 exec, -1
  v_and_b32_sdwa v28, s47, v6 dst_sel:WORD_1 dst_unused:UNUSED_PAD src0_sel:DWORD src1_sel:WORD_0
  v_and_b32_sdwa v29, s47, v7 dst_sel:WORD_1 dst_unused:UNUSED_PAD src0_sel:DWORD src1_sel:WORD_0
  s_nop 0
  v_pk_mul_f32 v[92:93], v[28:29], s[44:45]
  v_pk_mul_f32 v[94:95], v[28:29], s[42:43]
  v_cvt_pk_bf16_f32 v106, v92, v93
  v_cos_f32 v96, v94
  v_cos_f32 v97, v95
  v_lshlrev_b32 v92, 16, v106
  v_and_b32 v93, s46, v106
  v_pk_mul_f32 v[100:101], v[96:97], s[36:37]
  v_pk_mul_f32 v[94:95], v[92:93], s[42:43]
  v_pk_add_f32 v[90:91], v[96:97], v[96:97]
  v_cos_f32 v98, v94
  v_cos_f32 v99, v95
  v_pk_fma_f32 v[102:103], v[100:101], v[90:91], s[38:39]
  v_pk_mul_f32 v[104:105], v[98:99], s[36:37]
  v_lshrrev_b32 v88, 19, v10
  s_add_u32 s29, s13, 49152
  v_and_b32 v88, 0x1ff8, v88
  s_mov_b64 exec, s[84:85]
  buffer_load_dwordx2 v[36:37], v88, s[8:11], s29 offen
  s_mov_b64 exec, -1
  v_lshrrev_b32 v107, 9, v6
  s_waitcnt vmcnt(4)
  v_lshlrev_b32 v82, 16, v40
  v_and_b32 v83, s46, v40
  v_lshlrev_b32 v84, 16, v41
  v_and_b32 v85, s46, v41
  v_and_b32 v107, s12, v107
  v_pk_fma_f32 v[70:71], v[82:83], v[100:101], s[32:33] op_sel:[0,0,0] op_sel_hi:[1,0,1]
  v_pk_fma_f32 v[72:73], v[84:85], v[100:101], s[32:33] op_sel:[0,0,0] op_sel_hi:[1,0,1]
  v_pk_fma_f32 v[74:75], v[82:83], v[102:103], s[32:33] op_sel:[0,0,0] op_sel_hi:[1,0,1]
  v_pk_fma_f32 v[76:77], v[84:85], v[102:103], s[32:33] op_sel:[0,0,0] op_sel_hi:[1,0,1]
  v_pk_fma_f32 v[78:79], v[82:83], v[104:105], s[32:33] op_sel:[0,0,0] op_sel_hi:[1,0,1]
  v_pk_fma_f32 v[80:81], v[84:85], v[104:105], s[32:33] op_sel:[0,0,0] op_sel_hi:[1,0,1]
  v_lshl_add_u64 v[70:71], v[70:71], 0, s[34:35]
  v_lshl_add_u64 v[72:73], v[72:73], 0, s[34:35]
  v_lshl_add_u64 v[74:75], v[74:75], 0, s[34:35]
  v_lshl_add_u64 v[76:77], v[76:77], 0, s[34:35]
  v_lshl_add_u64 v[78:79], v[78:79], 0, s[34:35]
  v_lshl_add_u64 v[80:81], v[80:81], 0, s[34:35]
  s_mov_b64 exec, s[24:25]
  ds_add_u64 v107, v[70:71] offset:0
  ds_add_u64 v107, v[72:73] offset:5120
  ds_add_u64 v107, v[74:75] offset:10240
  ds_add_u64 v107, v[76:77] offset:15360
  ds_add_u64 v107, v[78:79] offset:20480
  ds_add_u64 v107, v[80:81] offset:25600
  s_mov_b64 exec, -1
  v_lshrrev_b32 v89, 19, v11
  s_add_u32 s29, s13, 57344
  v_and_b32 v89, 0x1ff8, v89
  s_mov_b64 exec, s[86:87]
  buffer_load_dwordx2 v[38:39], v89, s[8:11], s29 offen
  s_mov_b64 exec, -1
  v_lshrrev_b32 v107, 9, v7
  s_waitcnt vmcnt(4)
  v_lshlrev_b32 v82, 16, v42
  v_and_b32 v83, s46, v42
  v_lshlrev_b32 v84, 16, v43
  v_and_b32 v85, s46, v43
  v_and_b32 v107, s12, v107
  v_pk_fma_f32 v[70:71], v[82:83], v[100:101], s[32:33] op_sel:[0,1,0] op_sel_hi:[1,1,1]
  v_pk_fma_f32 v[72:73], v[84:85], v[100:101], s[32:33] op_sel:[0,1,0] op_sel_hi:[1,1,1]
  v_pk_fma_f32 v[74:75], v[82:83], v[102:103], s[32:33] op_sel:[0,1,0] op_sel_hi:[1,1,1]
  v_pk_fma_f32 v[76:77], v[84:85], v[102:103], s[32:33] op_sel:[0,1,0] op_sel_hi:[1,1,1]
  v_pk_fma_f32 v[78:79], v[82:83], v[104:105], s[32:33] op_sel:[0,1,0] op_sel_hi:[1,1,1]
  v_pk_fma_f32 v[80:81], v[84:85], v[104:105], s[32:33] op_sel:[0,1,0] op_sel_hi:[1,1,1]
  v_lshl_add_u64 v[70:71], v[70:71], 0, s[34:35]
  v_lshl_add_u64 v[72:73], v[72:73], 0, s[34:35]
  v_lshl_add_u64 v[74:75], v[74:75], 0, s[34:35]
  v_lshl_add_u64 v[76:77], v[76:77], 0, s[34:35]
  v_lshl_add_u64 v[78:79], v[78:79], 0, s[34:35]
  v_lshl_add_u64 v[80:81], v[80:81], 0, s[34:35]
  s_mov_b64 exec, s[26:27]
  ds_add_u64 v107, v[70:71] offset:0
  ds_add_u64 v107, v[72:73] offset:5120
  ds_add_u64 v107, v[74:75] offset:10240
  ds_add_u64 v107, v[76:77] offset:15360
  ds_add_u64 v107, v[78:79] offset:20480
  ds_add_u64 v107, v[80:81] offset:25600
  s_mov_b64 exec, -1
  v_and_b32_sdwa v28, s47, v8 dst_sel:WORD_1 dst_unused:UNUSED_PAD src0_sel:DWORD src1_sel:WORD_0
  v_and_b32_sdwa v29, s47, v9 dst_sel:WORD_1 dst_unused:UNUSED_PAD src0_sel:DWORD src1_sel:WORD_0
  s_nop 0
  v_pk_mul_f32 v[92:93], v[28:29], s[44:45]
  v_pk_mul_f32 v[94:95], v[28:29], s[42:43]
  v_cvt_pk_bf16_f32 v106, v92, v93
  v_cos_f32 v96, v94
  v_cos_f32 v97, v95
  v_lshlrev_b32 v92, 16, v106
  v_and_b32 v93, s46, v106
  v_pk_mul_f32 v[100:101], v[96:97], s[36:37]
  v_pk_mul_f32 v[94:95], v[92:93], s[42:43]
  v_pk_add_f32 v[90:91], v[96:97], v[96:97]
  v_cos_f32 v98, v94
  v_cos_f32 v99, v95
  v_pk_fma_f32 v[102:103], v[100:101], v[90:91], s[38:39]
  v_pk_mul_f32 v[104:105], v[98:99], s[36:37]
  v_lshrrev_b32 v86, 19, v12
  s_add_u32 s29, s13, 65536
  v_and_b32 v86, 0x1ff8, v86
  s_mov_b64 exec, s[88:89]
  buffer_load_dwordx2 v[40:41], v86, s[8:11], s29 offen
  s_mov_b64 exec, -1
  v_lshrrev_b32 v107, 9, v8
  s_waitcnt vmcnt(4)
  v_lshlrev_b32 v82, 16, v44
  v_and_b32 v83, s46, v44
  v_lshlrev_b32 v84, 16, v45
  v_and_b32 v85, s46, v45
  v_and_b32 v107, s12, v107
  v_pk_fma_f32 v[70:71], v[82:83], v[100:101], s[32:33] op_sel:[0,0,0] op_sel_hi:[1,0,1]
  v_pk_fma_f32 v[72:73], v[84:85], v[100:101], s[32:33] op_sel:[0,0,0] op_sel_hi:[1,0,1]
  v_pk_fma_f32 v[74:75], v[82:83], v[102:103], s[32:33] op_sel:[0,0,0] op_sel_hi:[1,0,1]
  v_pk_fma_f32 v[76:77], v[84:85], v[102:103], s[32:33] op_sel:[0,0,0] op_sel_hi:[1,0,1]
  v_pk_fma_f32 v[78:79], v[82:83], v[104:105], s[32:33] op_sel:[0,0,0] op_sel_hi:[1,0,1]
  v_pk_fma_f32 v[80:81], v[84:85], v[104:105], s[32:33] op_sel:[0,0,0] op_sel_hi:[1,0,1]
  v_lshl_add_u64 v[70:71], v[70:71], 0, s[34:35]
  v_lshl_add_u64 v[72:73], v[72:73], 0, s[34:35]
  v_lshl_add_u64 v[74:75], v[74:75], 0, s[34:35]
  v_lshl_add_u64 v[76:77], v[76:77], 0, s[34:35]
  v_lshl_add_u64 v[78:79], v[78:79], 0, s[34:35]
  v_lshl_add_u64 v[80:81], v[80:81], 0, s[34:35]
  s_mov_b64 exec, s[80:81]
  ds_add_u64 v107, v[70:71] offset:0
  ds_add_u64 v107, v[72:73] offset:5120
  ds_add_u64 v107, v[74:75] offset:10240
  ds_add_u64 v107, v[76:77] offset:15360
  ds_add_u64 v107, v[78:79] offset:20480
  ds_add_u64 v107, v[80:81] offset:25600
  s_mov_b64 exec, -1
  v_lshrrev_b32 v87, 19, v13
  s_add_u32 s29, s13, 73728
  v_and_b32 v87, 0x1ff8, v87
  s_mov_b64 exec, s[90:91]
  buffer_load_dwordx2 v[42:43], v87, s[8:11], s29 offen
  s_mov_b64 exec, -1
  v_lshrrev_b32 v107, 9, v9
  s_waitcnt vmcnt(4)
  v_lshlrev_b32 v82, 16, v46
  v_and_b32 v83, s46, v46
  v_lshlrev_b32 v84, 16, v47
  v_and_b32 v85, s46, v47
  v_and_b32 v107, s12, v107
  v_pk_fma_f32 v[70:71], v[82:83], v[100:101], s[32:33] op_sel:[0,1,0] op_sel_hi:[1,1,1]
  v_pk_fma_f32 v[72:73], v[84:85], v[100:101], s[32:33] op_sel:[0,1,0] op_sel_hi:[1,1,1]
  v_pk_fma_f32 v[74:75], v[82:83], v[102:103], s[32:33] op_sel:[0,1,0] op_sel_hi:[1,1,1]
  v_pk_fma_f32 v[76:77], v[84:85], v[102:103], s[32:33] op_sel:[0,1,0] op_sel_hi:[1,1,1]
  v_pk_fma_f32 v[78:79], v[82:83], v[104:105], s[32:33] op_sel:[0,1,0] op_sel_hi:[1,1,1]
  v_pk_fma_f32 v[80:81], v[84:85], v[104:105], s[32:33] op_sel:[0,1,0] op_sel_hi:[1,1,1]
  v_lshl_add_u64 v[70:71], v[70:71], 0, s[34:35]
  v_lshl_add_u64 v[72:73], v[72:73], 0, s[34:35]
  v_lshl_add_u64 v[74:75], v[74:75], 0, s[34:35]
  v_lshl_add_u64 v[76:77], v[76:77], 0, s[34:35]
  v_lshl_add_u64 v[78:79], v[78:79], 0, s[34:35]
  v_lshl_add_u64 v[80:81], v[80:81], 0, s[34:35]
  s_mov_b64 exec, s[82:83]
  ds_add_u64 v107, v[70:71] offset:0
  ds_add_u64 v107, v[72:73] offset:5120
  ds_add_u64 v107, v[74:75] offset:10240
  ds_add_u64 v107, v[76:77] offset:15360
  ds_add_u64 v107, v[78:79] offset:20480
  ds_add_u64 v107, v[80:81] offset:25600
  s_mov_b64 exec, -1
  v_and_b32_sdwa v28, s47, v10 dst_sel:WORD_1 dst_unused:UNUSED_PAD src0_sel:DWORD src1_sel:WORD_0
  v_and_b32_sdwa v29, s47, v11 dst_sel:WORD_1 dst_unused:UNUSED_PAD src0_sel:DWORD src1_sel:WORD_0
  s_nop 0
  v_pk_mul_f32 v[92:93], v[28:29], s[44:45]
  v_pk_mul_f32 v[94:95], v[28:29], s[42:43]
  v_cvt_pk_bf16_f32 v106, v92, v93
  v_cos_f32 v96, v94
  v_cos_f32 v97, v95
  v_lshlrev_b32 v92, 16, v106
  v_and_b32 v93, s46, v106
  v_pk_mul_f32 v[100:101], v[96:97], s[36:37]
  v_pk_mul_f32 v[94:95], v[92:93], s[42:43]
  v_pk_add_f32 v[90:91], v[96:97], v[96:97]
  v_cos_f32 v98, v94
  v_cos_f32 v99, v95
  v_pk_fma_f32 v[102:103], v[100:101], v[90:91], s[38:39]
  v_pk_mul_f32 v[104:105], v[98:99], s[36:37]
  s_mov_b64 exec, s[92:93]
  buffer_load_dwordx2 v[44:45], v16, s[8:11], 0 offen
  s_mov_b64 exec, -1
  v_lshrrev_b32 v107, 9, v10
  s_waitcnt vmcnt(4)
  v_lshlrev_b32 v82, 16, v36
  v_and_b32 v83, s46, v36
  v_lshlrev_b32 v84, 16, v37
  v_and_b32 v85, s46, v37
  v_and_b32 v107, s12, v107
  v_pk_fma_f32 v[70:71], v[82:83], v[100:101], s[32:33] op_sel:[0,0,0] op_sel_hi:[1,0,1]
  v_pk_fma_f32 v[72:73], v[84:85], v[100:101], s[32:33] op_sel:[0,0,0] op_sel_hi:[1,0,1]
  v_pk_fma_f32 v[74:75], v[82:83], v[102:103], s[32:33] op_sel:[0,0,0] op_sel_hi:[1,0,1]
  v_pk_fma_f32 v[76:77], v[84:85], v[102:103], s[32:33] op_sel:[0,0,0] op_sel_hi:[1,0,1]
  v_pk_fma_f32 v[78:79], v[82:83], v[104:105], s[32:33] op_sel:[0,0,0] op_sel_hi:[1,0,1]
  v_pk_fma_f32 v[80:81], v[84:85], v[104:105], s[32:33] op_sel:[0,0,0] op_sel_hi:[1,0,1]
  v_lshl_add_u64 v[70:71], v[70:71], 0, s[34:35]
  v_lshl_add_u64 v[72:73], v[72:73], 0, s[34:35]
  v_lshl_add_u64 v[74:75], v[74:75], 0, s[34:35]
  v_lshl_add_u64 v[76:77], v[76:77], 0, s[34:35]
  v_lshl_add_u64 v[78:79], v[78:79], 0, s[34:35]
  v_lshl_add_u64 v[80:81], v[80:81], 0, s[34:35]
  s_mov_b64 exec, s[84:85]
  ds_add_u64 v107, v[70:71] offset:0
  ds_add_u64 v107, v[72:73] offset:5120
  ds_add_u64 v107, v[74:75] offset:10240
  ds_add_u64 v107, v[76:77] offset:15360
  ds_add_u64 v107, v[78:79] offset:20480
  ds_add_u64 v107, v[80:81] offset:25600
  s_mov_b64 exec, -1
  s_mov_b64 exec, s[94:95]
  buffer_load_dwordx2 v[46:47], v17, s[8:11], 0 offen
  s_mov_b64 exec, -1
  v_lshrrev_b32 v107, 9, v11
  s_waitcnt vmcnt(4)
  v_lshlrev_b32 v82, 16, v38
  v_and_b32 v83, s46, v38
  v_lshlrev_b32 v84, 16, v39
  v_and_b32 v85, s46, v39
  v_and_b32 v107, s12, v107
  v_pk_fma_f32 v[70:71], v[82:83], v[100:101], s[32:33] op_sel:[0,1,0] op_sel_hi:[1,1,1]
  v_pk_fma_f32 v[72:73], v[84:85], v[100:101], s[32:33] op_sel:[0,1,0] op_sel_hi:[1,1,1]
  v_pk_fma_f32 v[74:75], v[82:83], v[102:103], s[32:33] op_sel:[0,1,0] op_sel_hi:[1,1,1]
  v_pk_fma_f32 v[76:77], v[84:85], v[102:103], s[32:33] op_sel:[0,1,0] op_sel_hi:[1,1,1]
  v_pk_fma_f32 v[78:79], v[82:83], v[104:105], s[32:33] op_sel:[0,1,0] op_sel_hi:[1,1,1]
  v_pk_fma_f32 v[80:81], v[84:85], v[104:105], s[32:33] op_sel:[0,1,0] op_sel_hi:[1,1,1]
  v_lshl_add_u64 v[70:71], v[70:71], 0, s[34:35]
  v_lshl_add_u64 v[72:73], v[72:73], 0, s[34:35]
  v_lshl_add_u64 v[74:75], v[74:75], 0, s[34:35]
  v_lshl_add_u64 v[76:77], v[76:77], 0, s[34:35]
  v_lshl_add_u64 v[78:79], v[78:79], 0, s[34:35]
  v_lshl_add_u64 v[80:81], v[80:81], 0, s[34:35]
  s_mov_b64 exec, s[86:87]
  ds_add_u64 v107, v[70:71] offset:0
  ds_add_u64 v107, v[72:73] offset:5120
  ds_add_u64 v107, v[74:75] offset:10240
  ds_add_u64 v107, v[76:77] offset:15360
  ds_add_u64 v107, v[78:79] offset:20480
  ds_add_u64 v107, v[80:81] offset:25600
  s_mov_b64 exec, -1
  v_and_b32_sdwa v28, s47, v12 dst_sel:WORD_1 dst_unused:UNUSED_PAD src0_sel:DWORD src1_sel:WORD_0
  v_and_b32_sdwa v29, s47, v13 dst_sel:WORD_1 dst_unused:UNUSED_PAD src0_sel:DWORD src1_sel:WORD_0
  s_nop 0
  v_pk_mul_f32 v[92:93], v[28:29], s[44:45]
  v_pk_mul_f32 v[94:95], v[28:29], s[42:43]
  v_cvt_pk_bf16_f32 v106, v92, v93
  v_cos_f32 v96, v94
  v_cos_f32 v97, v95
  v_lshlrev_b32 v92, 16, v106
  v_and_b32 v93, s46, v106
  v_pk_mul_f32 v[100:101], v[96:97], s[36:37]
  v_pk_mul_f32 v[94:95], v[92:93], s[42:43]
  v_pk_add_f32 v[90:91], v[96:97], v[96:97]
  v_cos_f32 v98, v94
  v_cos_f32 v99, v95
  v_pk_fma_f32 v[102:103], v[100:101], v[90:91], s[38:39]
  v_pk_mul_f32 v[104:105], v[98:99], s[36:37]
  v_lshrrev_b32 v107, 9, v12
  s_waitcnt vmcnt(3)
  v_lshlrev_b32 v82, 16, v40
  v_and_b32 v83, s46, v40
  v_lshlrev_b32 v84, 16, v41
  v_and_b32 v85, s46, v41
  v_and_b32 v107, s12, v107
  v_pk_fma_f32 v[70:71], v[82:83], v[100:101], s[32:33] op_sel:[0,0,0] op_sel_hi:[1,0,1]
  v_pk_fma_f32 v[72:73], v[84:85], v[100:101], s[32:33] op_sel:[0,0,0] op_sel_hi:[1,0,1]
  v_pk_fma_f32 v[74:75], v[82:83], v[102:103], s[32:33] op_sel:[0,0,0] op_sel_hi:[1,0,1]
  v_pk_fma_f32 v[76:77], v[84:85], v[102:103], s[32:33] op_sel:[0,0,0] op_sel_hi:[1,0,1]
  v_pk_fma_f32 v[78:79], v[82:83], v[104:105], s[32:33] op_sel:[0,0,0] op_sel_hi:[1,0,1]
  v_pk_fma_f32 v[80:81], v[84:85], v[104:105], s[32:33] op_sel:[0,0,0] op_sel_hi:[1,0,1]
  v_lshl_add_u64 v[70:71], v[70:71], 0, s[34:35]
  v_lshl_add_u64 v[72:73], v[72:73], 0, s[34:35]
  v_lshl_add_u64 v[74:75], v[74:75], 0, s[34:35]
  v_lshl_add_u64 v[76:77], v[76:77], 0, s[34:35]
  v_lshl_add_u64 v[78:79], v[78:79], 0, s[34:35]
  v_lshl_add_u64 v[80:81], v[80:81], 0, s[34:35]
  s_mov_b64 exec, s[88:89]
  ds_add_u64 v107, v[70:71] offset:0
  ds_add_u64 v107, v[72:73] offset:5120
  ds_add_u64 v107, v[74:75] offset:10240
  ds_add_u64 v107, v[76:77] offset:15360
  ds_add_u64 v107, v[78:79] offset:20480
  ds_add_u64 v107, v[80:81] offset:25600
  s_mov_b64 exec, -1
  v_lshrrev_b32 v107, 9, v13
  s_waitcnt vmcnt(2)
  v_lshlrev_b32 v82, 16, v42
  v_and_b32 v83, s46, v42
  v_lshlrev_b32 v84, 16, v43
  v_and_b32 v85, s46, v43
  v_and_b32 v107, s12, v107
  v_pk_fma_f32 v[70:71], v[82:83], v[100:101], s[32:33] op_sel:[0,1,0] op_sel_hi:[1,1,1]
  v_pk_fma_f32 v[72:73], v[84:85], v[100:101], s[32:33] op_sel:[0,1,0] op_sel_hi:[1,1,1]
  v_pk_fma_f32 v[74:75], v[82:83], v[102:103], s[32:33] op_sel:[0,1,0] op_sel_hi:[1,1,1]
  v_pk_fma_f32 v[76:77], v[84:85], v[102:103], s[32:33] op_sel:[0,1,0] op_sel_hi:[1,1,1]
  v_pk_fma_f32 v[78:79], v[82:83], v[104:105], s[32:33] op_sel:[0,1,0] op_sel_hi:[1,1,1]
  v_pk_fma_f32 v[80:81], v[84:85], v[104:105], s[32:33] op_sel:[0,1,0] op_sel_hi:[1,1,1]
  v_lshl_add_u64 v[70:71], v[70:71], 0, s[34:35]
  v_lshl_add_u64 v[72:73], v[72:73], 0, s[34:35]
  v_lshl_add_u64 v[74:75], v[74:75], 0, s[34:35]
  v_lshl_add_u64 v[76:77], v[76:77], 0, s[34:35]
  v_lshl_add_u64 v[78:79], v[78:79], 0, s[34:35]
  v_lshl_add_u64 v[80:81], v[80:81], 0, s[34:35]
  s_mov_b64 exec, s[90:91]
  ds_add_u64 v107, v[70:71] offset:0
  ds_add_u64 v107, v[72:73] offset:5120
  ds_add_u64 v107, v[74:75] offset:10240
  ds_add_u64 v107, v[76:77] offset:15360
  ds_add_u64 v107, v[78:79] offset:20480
  ds_add_u64 v107, v[80:81] offset:25600
  s_mov_b64 exec, -1
  v_and_b32_sdwa v28, s47, v14 dst_sel:WORD_1 dst_unused:UNUSED_PAD src0_sel:DWORD src1_sel:WORD_0
  v_mov_b32 v29, 0
  s_nop 0
  v_pk_mul_f32 v[92:93], v[28:29], s[44:45]
  v_pk_mul_f32 v[94:95], v[28:29], s[42:43]
  v_cvt_pk_bf16_f32 v106, v92, v93
  v_cos_f32 v96, v94
  v_cos_f32 v97, v95
  v_lshlrev_b32 v92, 16, v106
  v_and_b32 v93, s46, v106
  v_pk_mul_f32 v[100:101], v[96:97], s[36:37]
  v_pk_mul_f32 v[94:95], v[92:93], s[42:43]
  v_pk_add_f32 v[90:91], v[96:97], v[96:97]
  v_cos_f32 v98, v94
  v_cos_f32 v99, v95
  v_pk_fma_f32 v[102:103], v[100:101], v[90:91], s[38:39]
  v_pk_mul_f32 v[104:105], v[98:99], s[36:37]
  v_lshrrev_b32 v107, 9, v14
  s_waitcnt vmcnt(1)
  v_lshlrev_b32 v82, 16, v44
  v_and_b32 v83, s46, v44
  v_lshlrev_b32 v84, 16, v45
  v_and_b32 v85, s46, v45
  v_and_b32 v107, s12, v107
  v_pk_fma_f32 v[70:71], v[82:83], v[100:101], s[32:33] op_sel:[0,0,0] op_sel_hi:[1,0,1]
  v_pk_fma_f32 v[72:73], v[84:85], v[100:101], s[32:33] op_sel:[0,0,0] op_sel_hi:[1,0,1]
  v_pk_fma_f32 v[74:75], v[82:83], v[102:103], s[32:33] op_sel:[0,0,0] op_sel_hi:[1,0,1]
  v_pk_fma_f32 v[76:77], v[84:85], v[102:103], s[32:33] op_sel:[0,0,0] op_sel_hi:[1,0,1]
  v_pk_fma_f32 v[78:79], v[82:83], v[104:105], s[32:33] op_sel:[0,0,0] op_sel_hi:[1,0,1]
  v_pk_fma_f32 v[80:81], v[84:85], v[104:105], s[32:33] op_sel:[0,0,0] op_sel_hi:[1,0,1]
  v_lshl_add_u64 v[70:71], v[70:71], 0, s[34:35]
  v_lshl_add_u64 v[72:73], v[72:73], 0, s[34:35]
  v_lshl_add_u64 v[74:75], v[74:75], 0, s[34:35]
  v_lshl_add_u64 v[76:77], v[76:77], 0, s[34:35]
  v_lshl_add_u64 v[78:79], v[78:79], 0, s[34:35]
  v_lshl_add_u64 v[80:81], v[80:81], 0, s[34:35]
  s_mov_b64 exec, s[92:93]
  ds_add_u64 v107, v[70:71] offset:0
  ds_add_u64 v107, v[72:73] offset:5120
  ds_add_u64 v107, v[74:75] offset:10240
  ds_add_u64 v107, v[76:77] offset:15360
  ds_add_u64 v107, v[78:79] offset:20480
  ds_add_u64 v107, v[80:81] offset:25600
  s_mov_b64 exec, -1
  s_cmp_eq_u64 s[94:95], 0
  s_cbranch_scc1 L_k2_skip11
  v_and_b32_sdwa v28, s47, v15 dst_sel:WORD_1 dst_unused:UNUSED_PAD src0_sel:DWORD src1_sel:WORD_0
  v_mov_b32 v29, 0
  s_nop 0
  v_pk_mul_f32 v[92:93], v[28:29], s[44:45]
  v_pk_mul_f32 v[94:95], v[28:29], s[42:43]
  v_cvt_pk_bf16_f32 v106, v92, v93
  v_cos_f32 v96, v94
  v_cos_f32 v97, v95
  v_lshlrev_b32 v92, 16, v106
  v_and_b32 v93, s46, v106
  v_pk_mul_f32 v[100:101], v[96:97], s[36:37]
  v_pk_mul_f32 v[94:95], v[92:93], s[42:43]
  v_pk_add_f32 v[90:91], v[96:97], v[96:97]
  v_cos_f32 v98, v94
  v_cos_f32 v99, v95
  v_pk_fma_f32 v[102:103], v[100:101], v[90:91], s[38:39]
  v_pk_mul_f32 v[104:105], v[98:99], s[36:37]
  v_lshrrev_b32 v107, 9, v15
  s_waitcnt vmcnt(0)
  v_lshlrev_b32 v82, 16, v46
  v_and_b32 v83, s46, v46
  v_lshlrev_b32 v84, 16, v47
  v_and_b32 v85, s46, v47
  v_and_b32 v107, s12, v107
  v_pk_fma_f32 v[70:71], v[82:83], v[100:101], s[32:33] op_sel:[0,0,0] op_sel_hi:[1,0,1]
  v_pk_fma_f32 v[72:73], v[84:85], v[100:101], s[32:33] op_sel:[0,0,0] op_sel_hi:[1,0,1]
  v_pk_fma_f32 v[74:75], v[82:83], v[102:103], s[32:33] op_sel:[0,0,0] op_sel_hi:[1,0,1]
  v_pk_fma_f32 v[76:77], v[84:85], v[102:103], s[32:33] op_sel:[0,0,0] op_sel_hi:[1,0,1]
  v_pk_fma_f32 v[78:79], v[82:83], v[104:105], s[32:33] op_sel:[0,0,0] op_sel_hi:[1,0,1]
  v_pk_fma_f32 v[80:81], v[84:85], v[104:105], s[32:33] op_sel:[0,0,0] op_sel_hi:[1,0,1]
  v_lshl_add_u64 v[70:71], v[70:71], 0, s[34:35]
  v_lshl_add_u64 v[72:73], v[72:73], 0, s[34:35]
  v_lshl_add_u64 v[74:75], v[74:75], 0, s[34:35]
  v_lshl_add_u64 v[76:77], v[76:77], 0, s[34:35]
  v_lshl_add_u64 v[78:79], v[78:79], 0, s[34:35]
  v_lshl_add_u64 v[80:81], v[80:81], 0, s[34:35]
  s_mov_b64 exec, s[94:95]
  ds_add_u64 v107, v[70:71] offset:0
  ds_add_u64 v107, v[72:73] offset:5120
  ds_add_u64 v107, v[74:75] offset:10240
  ds_add_u64 v107, v[76:77] offset:15360
  ds_add_u64 v107, v[78:79] offset:20480
  ds_add_u64 v107, v[80:81] offset:25600
  s_mov_b64 exec, -1
L_k2_skip11:
  s_cmp_lg_u64 s[96:97], 0
  s_cbranch_scc1 L_k2_big
L_k2_fastdone:
  s_waitcnt lgkmcnt(0)
  s_barrier
  s_cmp_gt_u32 s30, 9
  s_cbranch_scc1 L_k2_end
  ds_read_b64 v[90:91], v1 offset:0
  ds_read_b64 v[92:93], v1 offset:5120
  ds_read_b64 v[94:95], v1 offset:10240
  ds_read_b64 v[96:97], v1 offset:15360
  ds_read_b64 v[98:99], v1 offset:20480
  ds_read_b64 v[100:101], v1 offset:25600
  s_waitcnt lgkmcnt(0)
  v_ashrrev_i32 v102, 31, v90
  v_ashrrev_i32 v103, 31, v92
  v_ashrrev_i32 v104, 31, v94
  v_ashrrev_i32 v105, 31, v96
  v_ashrrev_i32 v106, 31, v98
  v_ashrrev_i32 v107, 31, v100
  v_sub_u32 v91, v91, v102
  v_sub_u32 v93, v93, v103
  v_sub_u32 v95, v95, v104
  v_sub_u32 v97, v97, v105
  v_sub_u32 v99, v99, v106
  v_sub_u32 v101, v101, v107
  v_cvt_f32_i32 v90, v90
  v_cvt_f32_i32 v91, v91
  v_cvt_f32_i32 v92, v92
  v_cvt_f32_i32 v93, v93
  v_cvt_f32_i32 v94, v94
  v_cvt_f32_i32 v95, v95
  v_cvt_f32_i32 v96, v96
  v_cvt_f32_i32 v97, v97
  v_cvt_f32_i32 v98, v98
  v_cvt_f32_i32 v99, v99
  v_cvt_f32_i32 v100, v100
  v_cvt_f32_i32 v101, v101
  v_pk_mul_f32 v[90:91], v[90:91], s[40:41]
  v_pk_mul_f32 v[92:93], v[92:93], s[40:41]
  v_pk_mul_f32 v[94:95], v[94:95], s[40:41]
  v_pk_mul_f32 v[96:97], v[96:97], s[40:41]
  v_pk_mul_f32 v[98:99], v[98:99], s[40:41]
  v_pk_mul_f32 v[100:101], v[100:101], s[40:41]
L_k2_epi:
  v_pk_mul_f32 v[102:103], v[90:91], s[48:49] op_sel:[0,0] op_sel_hi:[0,1]
  v_pk_fma_f32 v[102:103], v[90:91], s[52:53], v[102:103] op_sel:[1,0,0] op_sel_hi:[1,1,1]
  v_pk_fma_f32 v[102:103], v[92:93], s[56:57], v[102:103] op_sel:[0,0,0] op_sel_hi:[0,1,1]
  v_pk_fma_f32 v[102:103], v[92:93], s[60:61], v[102:103] op_sel:[1,0,0] op_sel_hi:[1,1,1]
  v_pk_mul_f32 v[104:105], v[90:91], s[50:51] op_sel:[0,0] op_sel_hi:[0,1]
  v_pk_fma_f32 v[104:105], v[90:91], s[54:55], v[104:105] op_sel:[1,0,0] op_sel_hi:[1,1,1]
  v_pk_fma_f32 v[104:105], v[92:93], s[58:59], v[104:105] op_sel:[0,0,0] op_sel_hi:[0,1,1]
  v_pk_fma_f32 v[104:105], v[92:93], s[62:63], v[104:105] op_sel:[1,0,0] op_sel_hi:[1,1,1]
  v_pk_mul_f32 v[106:107], v[94:95], s[48:49] op_sel:[0,0] op_sel_hi:[0,1]
  v_pk_fma_f32 v[106:107], v[94:95], s[52:53], v[106:107] op_sel:[1,0,0] op_sel_hi:[1,1,1]
  v_pk_fma_f32 v[106:107], v[96:97], s[56:57], v[106:107] op_sel:[0,0,0] op_sel_hi:[0,1,1]
  v_pk_fma_f32 v[106:107], v[96:97], s[60:61], v[106:107] op_sel:[1,0,0] op_sel_hi:[1,1,1]
  v_pk_mul_f32 v[108:109], v[94:95], s[50:51] op_sel:[0,0] op_sel_hi:[0,1]
  v_pk_fma_f32 v[108:109], v[94:95], s[54:55], v[108:109] op_sel:[1,0,0] op_sel_hi:[1,1,1]
  v_pk_fma_f32 v[108:109], v[96:97], s[58:59], v[108:109] op_sel:[0,0,0] op_sel_hi:[0,1,1]
  v_pk_fma_f32 v[108:109], v[96:97], s[62:63], v[108:109] op_sel:[1,0,0] op_sel_hi:[1,1,1]
  v_pk_mul_f32 v[110:111], v[98:99], s[48:49] op_sel:[0,0] op_sel_hi:[0,1]
  v_pk_fma_f32 v[110:111], v[98:99], s[52:53], v[110:111] op_sel:[1,0,0] op_sel_hi:[1,1,1]
  v_pk_fma_f32 v[110:111], v[100:101], s[56:57], v[110:111] op_sel:[0,0,0] op_sel_hi:[0,1,1]
  v_pk_fma_f32 v[110:111], v[100:101], s[60:61], v[110:111] op_sel:[1,0,0] op_sel_hi:[1,1,1]
  v_pk_mul_f32 v[112:113], v[98:99], s[50:51] op_sel:[0,0] op_sel_hi:[0,1]
  v_pk_fma_f32 v[112:113], v[98:99], s[54:55], v[112:113] op_sel:[1,0,0] op_sel_hi:[1,1,1]
  v_pk_fma_f32 v[112:113], v[100:101], s[58:59], v[112:113] op_sel:[0,0,0] op_sel_hi:[0,1,1]
  v_pk_fma_f32 v[112:113], v[100:101], s[62:63], v[112:113] op_sel:[1,0,0] op_sel_hi:[1,1,1]
  v_pk_mul_f32 v[114:115], v[102:103], v[48:49]
  v_pk_fma_f32 v[114:115], v[106:107], v[52:53], v[114:115]
  v_pk_fma_f32 v[114:115], v[110:111], v[56:57], v[114:115]
  v_pk_mul_f32 v[116:117], v[104:105], v[50:51]
  v_pk_fma_f32 v[116:117], v[108:109], v[54:55], v[116:117]
  v_pk_fma_f32 v[116:117], v[112:113], v[58:59], v[116:117]
  v_pk_mul_f32 v[118:119], v[114:115], s[64:65] op_sel:[0,0] op_sel_hi:[0,1]
  v_pk_fma_f32 v[118:119], v[114:115], s[68:69], v[118:119] op_sel:[1,0,0] op_sel_hi:[1,1,1]
  v_pk_fma_f32 v[118:119], v[116:117], s[72:73], v[118:119] op_sel:[0,0,0] op_sel_hi:[0,1,1]
  v_pk_fma_f32 v[118:119], v[116:117], s[76:77], v[118:119] op_sel:[1,0,0] op_sel_hi:[1,1,1]
  v_pk_mul_f32 v[120:121], v[114:115], s[66:67] op_sel:[0,0] op_sel_hi:[0,1]
  v_pk_fma_f32 v[120:121], v[114:115], s[70:71], v[120:121] op_sel:[1,0,0] op_sel_hi:[1,1,1]
  v_pk_fma_f32 v[120:121], v[116:117], s[74:75], v[120:121] op_sel:[0,0,0] op_sel_hi:[0,1,1]
  v_pk_fma_f32 v[120:121], v[116:117], s[78:79], v[120:121] op_sel:[1,0,0] op_sel_hi:[1,1,1]
  v_lshlrev_b32 v90, 16, v64
  v_and_b32 v91, s46, v64
  v_lshlrev_b32 v92, 16, v65
  v_and_b32 v93, s46, v65
  v_pk_fma_f32 v[118:119], v[118:119], v[60:61], v[90:91]
  v_pk_fma_f32 v[120:121], v[120:121], v[62:63], v[92:93]
  s_nop 0
  v_cvt_pk_bf16_f32 v114, v118, v119
  v_cvt_pk_bf16_f32 v115, v120, v121
  buffer_store_dwordx2 v[114:115], v1, s[20:23], 0 offen
  s_endpgm
L_k2_big:
  s_ff1_i32_b64 s98, s[96:97]
  s_bitset0_b64 s[96:97], s98
  v_readlane_b32 s99, v117, s98
  s_mul_i32 s28, s98, 516
  s_add_u32 s28, s28, s15
  s_lshl_b32 s29, s98, 13
  s_add_u32 s29, s29, s13
  s_bfm_b64 s[92:93], s99, 0
  v_add_u32 v18, s28, v20
  s_mov_b64 exec, s[92:93]
  ds_read_b32 v14, v18
  s_waitcnt lgkmcnt(0)
  v_lshrrev_b32 v16, 19, v14
  v_and_b32 v16, s12, v16
  buffer_load_dwordx2 v[36:37], v16, s[8:11], s29 offen
  s_mov_b64 exec, -1
  v_and_b32_sdwa v28, s47, v14 dst_sel:WORD_1 dst_unused:UNUSED_PAD src0_sel:DWORD src1_sel:WORD_0
  v_mov_b32 v29, 0
  s_nop 0
  v_pk_mul_f32 v[92:93], v[28:29], s[44:45]
  v_pk_mul_f32 v[94:95], v[28:29], s[42:43]
  v_cvt_pk_bf16_f32 v106, v92, v93
  v_cos_f32 v96, v94
  v_cos_f32 v97, v95
  v_lshlrev_b32 v92, 16, v106
  v_and_b32 v93, s46, v106
  v_pk_mul_f32 v[100:101], v[96:97], s[36:37]
  v_pk_mul_f32 v[94:95], v[92:93], s[42:43]
  v_pk_add_f32 v[90:91], v[96:97], v[96:97]
  v_cos_f32 v98, v94
  v_cos_f32 v99, v95
  v_pk_fma_f32 v[102:103], v[100:101], v[90:91], s[38:39]
  v_pk_mul_f32 v[104:105], v[98:99], s[36:37]
  v_lshrrev_b32 v107, 9, v14
  s_waitcnt vmcnt(0)
  v_lshlrev_b32 v82, 16, v36
  v_and_b32 v83, s46, v36
  v_lshlrev_b32 v84, 16, v37
  v_and_b32 v85, s46, v37
  v_and_b32 v107, s12, v107
  v_pk_fma_f32 v[70:71], v[82:83], v[100:101], s[32:33] op_sel:[0,0,0] op_sel_hi:[1,0,1]
  v_pk_fma_f32 v[72:73], v[84:85], v[100:101], s[32:33] op_sel:[0,0,0] op_sel_hi:[1,0,1]
  v_pk_fma_f32 v[74:75], v[82:83], v[102:103], s[32:33] op_sel:[0,0,0] op_sel_hi:[1,0,1]
  v_pk_fma_f32 v[76:77], v[84:85], v[102:103], s[32:33] op_sel:[0,0,0] op_sel_hi:[1,0,1]
  v_pk_fma_f32 v[78:79], v[82:83], v[104:105], s[32:33] op_sel:[0,0,0] op_sel_hi:[1,0,1]
  v_pk_fma_f32 v[80:81], v[84:85], v[104:105], s[32:33] op_sel:[0,0,0] op_sel_hi:[1,0,1]
  v_lshl_add_u64 v[70:71], v[70:71], 0, s[34:35]
  v_lshl_add_u64 v[72:73], v[72:73], 0, s[34:35]
  v_lshl_add_u64 v[74:75], v[74:75], 0, s[34:35]
  v_lshl_add_u64 v[76:77], v[76:77], 0, s[34:35]
  v_lshl_add_u64 v[78:79], v[78:79], 0, s[34:35]
  v_lshl_add_u64 v[80:81], v[80:81], 0, s[34:35]
  s_mov_b64 exec, s[92:93]
  ds_add_u64 v107, v[70:71] offset:0
  ds_add_u64 v107, v[72:73] offset:5120
  ds_add_u64 v107, v[74:75] offset:10240
  ds_add_u64 v107, v[76:77] offset:15360
  ds_add_u64 v107, v[78:79] offset:20480
  ds_add_u64 v107, v[80:81] offset:25600
  s_mov_b64 exec, -1
  s_cmp_lg_u64 s[96:97], 0
  s_cbranch_scc1 L_k2_big
  s_branch L_k2_fastdone
L_k2_slow0:
  s_waitcnt vmcnt(0) lgkmcnt(0)
  s_mov_b32 s47, 0x32800000
  s_load_dwordx4 s[12:15], s[0:1], 8
  s_load_dwordx2 s[16:17], s[0:1], 32
  s_mov_b32 s80, 0x3e22f983
  s_mov_b32 s81, 0x31dc9c88
  v_cmp_le_u32 vcc, 24, v2
  v_subrev_u32 v6, 24, v2
  v_mov_b32 v7, 128
  v_cndmask_b32 v6, v2, v6, vcc
  v_cndmask_b32 v7, 0, v7, vcc
  v_and_b32 v8, 7, v6
  v_lshrrev_b32 v6, 3, v6
  v_lshl_add_u32 v7, v8, 4, v7
  v_lshl_add_u32 v4, v6, 2, v7
  v_add3_u32 v5, v6, v7, 12
  s_waitcnt lgkmcnt(0)
  s_mov_b32 s88, s12
  s_mov_b32 s89, s13
  s_mov_b32 s90, 0x9c4000
  s_mov_b32 s91, 0x20000
  s_mov_b32 s92, s14
  s_mov_b32 s93, s15
  s_mov_b32 s94, 0x9c4000
  s_mov_b32 s95, 0x20000
  s_mov_b32 s96, s16
  s_mov_b32 s97, s17
  s_mov_b32 s98, 0x4e2000
  s_mov_b32 s99, 0x20000
  s_mov_b32 s82, 0
L_k2_sp_piece:
  v_readlane_b32 s83, v34, s82
  s_lshl_b32 s84, s30, 4
  s_add_u32 s84, s84, s82
  s_cmp_gt_u32 s83, 56
  s_cbranch_scc1 L_k2_sp_raw
  s_mul_i32 s85, s84, 65536
  s_lshl_b32 s87, s3, 8
  s_add_u32 s85, s85, s87
  v_cmp_gt_u32 vcc, 48, v2
  s_mov_b64 exec, vcc
  buffer_load_dword v88, v4, s[4:7], s85 offen
  buffer_load_ubyte v89, v5, s[4:7], s85 offen
  s_waitcnt vmcnt(0)
  v_cmpx_ne_u32 vcc, -1, v88
  v_and_b32 v90, 15, v88
  v_lshl_or_b32 v89, v90, 8, v89
  v_lshrrev_b32 v86, 11, v88
  v_lshrrev_b32 v87, 1, v88
  v_lshl_add_u32 v90, v89, 16, s47
  v_and_b32 v86, -8, v86
  v_and_b32 v87, 0x1ff8, v87
  buffer_load_dwordx2 v[106:107], v86, s[8:11], 0 offen
  v_add_f32 v91, v90, v90
  v_mul_f32 v92, s44, v90
  v_cvt_pk_bf16_f32 v92, v92, v92
  s_nop 0
  v_lshlrev_b32 v92, 16, v92
  v_mul_f32 v94, s80, v90
  v_mul_f32 v95, s80, v91
  v_mul_f32 v96, s80, v92
  v_fma_f32 v98, v90, s80, -v94
  v_fma_f32 v99, v91, s80, -v95
  v_fma_f32 v100, v92, s80, -v96
  v_fma_f32 v98, v90, s81, v98
  v_fma_f32 v99, v91, s81, v99
  v_fma_f32 v100, v92, s81, v100
  v_fract_f32 v94, v94
  v_fract_f32 v95, v95
  v_fract_f32 v96, v96
  v_add_f32 v94, v94, v98
  v_add_f32 v95, v95, v99
  v_add_f32 v96, v96, v100
  v_cos_f32 v102, v94
  v_cos_f32 v103, v95
  v_cos_f32 v104, v96
  s_waitcnt vmcnt(0)
  v_lshlrev_b32 v82, 16, v106
  v_and_b32 v83, s46, v106
  v_lshlrev_b32 v84, 16, v107
  v_and_b32 v85, s46, v107
  v_pk_mul_f32 v[70:71], v[82:83], v[102:103] op_sel:[0,0] op_sel_hi:[1,0]
  v_pk_mul_f32 v[72:73], v[84:85], v[102:103] op_sel:[0,0] op_sel_hi:[1,0]
  v_pk_mul_f32 v[74:75], v[82:83], v[102:103] op_sel:[0,1] op_sel_hi:[1,1]
  v_pk_mul_f32 v[76:77], v[84:85], v[102:103] op_sel:[0,1] op_sel_hi:[1,1]
  v_pk_mul_f32 v[78:79], v[82:83], v[104:105] op_sel:[0,0] op_sel_hi:[1,0]
  v_pk_mul_f32 v[80:81], v[84:85], v[104:105] op_sel:[0,0] op_sel_hi:[1,0]
  ds_add_f32 v87, v70 offset:0
  ds_add_f32 v87, v71 offset:4
  ds_add_f32 v87, v72 offset:5120
  ds_add_f32 v87, v73 offset:5124
  ds_add_f32 v87, v74 offset:10240
  ds_add_f32 v87, v75 offset:10244
  ds_add_f32 v87, v76 offset:15360
  ds_add_f32 v87, v77 offset:15364
  ds_add_f32 v87, v78 offset:20480
  ds_add_f32 v87, v79 offset:20484
  ds_add_f32 v87, v80 offset:25600
  ds_add_f32 v87, v81 offset:25604
  s_mov_b64 exec, -1
  s_sub_i32 s83, s83, 24
  s_cmp_le_i32 s83, 0
  s_cbranch_scc1 L_k2_sp_next
  s_mul_i32 s85, s84, 65792
  s_lshl_b32 s87, s3, 8
  s_add_u32 s85, s85, s87
  s_add_u32 s85, s85, 0x1100000
  v_lshlrev_b32 v86, 3, v2
  v_cmp_gt_u32 vcc, s83, v2
  s_mov_b64 exec, vcc
  buffer_load_dwordx2 v[88:89], v86, s[4:7], s85 offen
  s_waitcnt vmcnt(0)
  v_lshrrev_b32 v86, 11, v88
  v_lshrrev_b32 v87, 1, v88
  v_lshl_add_u32 v90, v89, 16, s47
  v_and_b32 v86, -8, v86
  v_and_b32 v87, 0x1ff8, v87
  buffer_load_dwordx2 v[106:107], v86, s[8:11], 0 offen
  v_add_f32 v91, v90, v90
  v_mul_f32 v92, s44, v90
  v_cvt_pk_bf16_f32 v92, v92, v92
  s_nop 0
  v_lshlrev_b32 v92, 16, v92
  v_mul_f32 v94, s80, v90
  v_mul_f32 v95, s80, v91
  v_mul_f32 v96, s80, v92
  v_fma_f32 v98, v90, s80, -v94
  v_fma_f32 v99, v91, s80, -v95
  v_fma_f32 v100, v92, s80, -v96
  v_fma_f32 v98, v90, s81, v98
  v_fma_f32 v99, v91, s81, v99
  v_fma_f32 v100, v92, s81, v100
  v_fract_f32 v94, v94
  v_fract_f32 v95, v95
  v_fract_f32 v96, v96
  v_add_f32 v94, v94, v98
  v_add_f32 v95, v95, v99
  v_add_f32 v96, v96, v100
  v_cos_f32 v102, v94
  v_cos_f32 v103, v95
  v_cos_f32 v104, v96
  s_waitcnt vmcnt(0)
  v_lshlrev_b32 v82, 16, v106
  v_and_b32 v83, s46, v106
  v_lshlrev_b32 v84, 16, v107
  v_and_b32 v85, s46, v107
  v_pk_mul_f32 v[70:71], v[82:83], v[102:103] op_sel:[0,0] op_sel_hi:[1,0]
  v_pk_mul_f32 v[72:73], v[84:85], v[102:103] op_sel:[0,0] op_sel_hi:[1,0]
  v_pk_mul_f32 v[74:75], v[82:83], v[102:103] op_sel:[0,1] op_sel_hi:[1,1]
  v_pk_mul_f32 v[76:77], v[84:85], v[102:103] op_sel:[0,1] op_sel_hi:[1,1]
  v_pk_mul_f32 v[78:79], v[82:83], v[104:105] op_sel:[0,0] op_sel_hi:[1,0]
  v_pk_mul_f32 v[80:81], v[84:85], v[104:105] op_sel:[0,0] op_sel_hi:[1,0]
  ds_add_f32 v87, v70 offset:0
  ds_add_f32 v87, v71 offset:4
  ds_add_f32 v87, v72 offset:5120
  ds_add_f32 v87, v73 offset:5124
  ds_add_f32 v87, v74 offset:10240
  ds_add_f32 v87, v75 offset:10244
  ds_add_f32 v87, v76 offset:15360
  ds_add_f32 v87, v77 offset:15364
  ds_add_f32 v87, v78 offset:20480
  ds_add_f32 v87, v79 offset:20484
  ds_add_f32 v87, v80 offset:25600
  ds_add_f32 v87, v81 offset:25604
  s_mov_b64 exec, -1
  s_branch L_k2_sp_next
L_k2_sp_raw:
  s_mov_b32 s86, 0
L_k2_sp_rawl:
  v_add_u32 v88, s86, v2
  s_mul_i32 s85, s84, 40000
  s_mul_i32 s87, s84, 20000
  v_mov_b32 v89, 10000
  v_cmp_lt_u32 vcc, v88, v89
  v_lshlrev_b32 v86, 2, v88
  v_lshlrev_b32 v87, 1, v88
  s_mov_b64 exec, vcc
  buffer_load_dword v88, v86, s[92:95], s85 offen
  buffer_load_dword v89, v86, s[88:91], s85 offen
  buffer_load_ushort v90, v87, s[96:99], s87 offen
  s_mul_i32 s87, s3, 625
  s_waitcnt vmcnt(0)
  v_subrev_u32 v88, s87, v88
  v_mov_b32 v87, 625
  v_lshlrev_b32 v86, 3, v89
  v_lshlrev_b32 v90, 16, v90
  v_cmpx_lt_u32 vcc, v88, v87
  v_lshlrev_b32 v87, 3, v88
  s_cbranch_execz L_k2_sp_rawn
  buffer_load_dwordx2 v[106:107], v86, s[8:11], 0 offen
  v_add_f32 v91, v90, v90
  v_mul_f32 v92, s44, v90
  v_cvt_pk_bf16_f32 v92, v92, v92
  s_nop 0
  v_lshlrev_b32 v92, 16, v92
  v_mul_f32 v94, s80, v90
  v_mul_f32 v95, s80, v91
  v_mul_f32 v96, s80, v92
  v_fma_f32 v98, v90, s80, -v94
  v_fma_f32 v99, v91, s80, -v95
  v_fma_f32 v100, v92, s80, -v96
  v_fma_f32 v98, v90, s81, v98
  v_fma_f32 v99, v91, s81, v99
  v_fma_f32 v100, v92, s81, v100
  v_fract_f32 v94, v94
  v_fract_f32 v95, v95
  v_fract_f32 v96, v96
  v_add_f32 v94, v94, v98
  v_add_f32 v95, v95, v99
  v_add_f32 v96, v96, v100
  v_cos_f32 v102, v94
  v_cos_f32 v103, v95
  v_cos_f32 v104, v96
  s_waitcnt vmcnt(0)
  v_lshlrev_b32 v82, 16, v106
  v_and_b32 v83, s46, v106
  v_lshlrev_b32 v84, 16, v107
  v_and_b32 v85, s46, v107
  v_pk_mul_f32 v[70:71], v[82:83], v[102:103] op_sel:[0,0] op_sel_hi:[1,0]
  v_pk_mul_f32 v[72:73], v[84:85], v[102:103] op_sel:[0,0] op_sel_hi:[1,0]
  v_pk_mul_f32 v[74:75], v[82:83], v[102:103] op_sel:[0,1] op_sel_hi:[1,1]
  v_pk_mul_f32 v[76:77], v[84:85], v[102:103] op_sel:[0,1] op_sel_hi:[1,1]
  v_pk_mul_f32 v[78:79], v[82:83], v[104:105] op_sel:[0,0] op_sel_hi:[1,0]
  v_pk_mul_f32 v[80:81], v[84:85], v[104:105] op_sel:[0,0] op_sel_hi:[1,0]
  ds_add_f32 v87, v70 offset:0
  ds_add_f32 v87, v71 offset:4
  ds_add_f32 v87, v72 offset:5120
  ds_add_f32 v87, v73 offset:5124
  ds_add_f32 v87, v74 offset:10240
  ds_add_f32 v87, v75 offset:10244
  ds_add_f32 v87, v76 offset:15360
  ds_add_f32 v87, v77 offset:15364
  ds_add_f32 v87, v78 offset:20480
  ds_add_f32 v87, v79 offset:20484
  ds_add_f32 v87, v80 offset:25600
  ds_add_f32 v87, v81 offset:25604
L_k2_sp_rawn:
  s_mov_b64 exec, -1
  s_add_u32 s86, s86, 64
  s_cmp_lt_u32 s86, 10000
  s_cbranch_scc1 L_k2_sp_rawl
L_k2_sp_next:
  s_add_u32 s82, s82, 1
  s_cmp_lt_u32 s82, 16
  s_cbranch_scc1 L_k2_sp_piece
  s_waitcnt vmcnt(0) lgkmcnt(0)
  s_barrier
  s_cmp_gt_u32 s30, 9
  s_cbranch_scc1 L_k2_end
  ds_read_b64 v[90:91], v1 offset:0
  ds_read_b64 v[92:93], v1 offset:5120
  ds_read_b64 v[94:95], v1 offset:10240
  ds_read_b64 v[96:97], v1 offset:15360
  ds_read_b64 v[98:99], v1 offset:20480
  ds_read_b64 v[100:101], v1 offset:25600
  s_waitcnt lgkmcnt(0)
  s_branch L_k2_epi
L_k2_end:
L_k2_exit:
  s_endpgm

.section .rodata,"a"
.p2align 6
.amdhsa_kernel gs_part_kernel
  .amdhsa_next_free_vgpr 128
  .amdhsa_next_free_sgpr 102
  .amdhsa_accum_offset 128
  .amdhsa_group_segment_fixed_size 0
  .amdhsa_kernarg_size 112
  .amdhsa_user_sgpr_count 2
  .amdhsa_user_sgpr_kernarg_segment_ptr 1
  .amdhsa_system_sgpr_workgroup_id_x 1
  .amdhsa_float_denorm_mode_32 3
.end_amdhsa_kernel

.p2align 6
.amdhsa_kernel gather_scatter__molecular_angular_gemnet__graph_kernel
  .amdhsa_next_free_vgpr 124
  .amdhsa_next_free_sgpr 102
  .amdhsa_accum_offset 124
  .amdhsa_group_segment_fixed_size 0
  .amdhsa_kernarg_size 112
  .amdhsa_user_sgpr_count 2
  .amdhsa_user_sgpr_kernarg_segment_ptr 1
  .amdhsa_system_sgpr_workgroup_id_x 1
  .amdhsa_float_denorm_mode_32 3
.end_amdhsa_kernel
```
